```python
import torch

def _softmax(x, axis=-1):
    return torch.softmax(x, dim=axis)

def _gelu(x):
    return torch.nn.functional.gelu(x, approximate='tanh')

def _silu(x):
    return torch.nn.functional.silu(x)

def _sigmoid(x):
    return torch.sigmoid(x)

def _layernorm(x, axis=-1, eps=1e-05):
    m = x.mean(dim=axis, keepdim=True)
    v = x.var(dim=axis, keepdim=True, unbiased=False)
    return (x - m) / torch.sqrt(v + eps)

def _scatter_add(tgt, idx, src, axis=0):
    return tgt.clone().index_add_(axis, idx, src)

def _segment_sum(src, seg, n):
    out = torch.zeros((n,) + src.shape[1:], dtype=src.dtype)
    return out.index_add_(0, seg, src)

def _pad(x, pw):
    flat = tuple((v for pair in reversed(pw) for v in pair))
    return torch.nn.functional.pad(x, flat)
kernel_name = 'adaLN_cond__gqa_block_cached__swiglu_ffn__decode'

def setup_inputs():

    _w = lambda a: (lambda t: t.to(torch.bfloat16) if t.is_floating_point() else t)(torch.as_tensor(a))

    def _A_setup():
        B, Sq, D = (2, 1, 576)
        Hq, Hkv, Sk, Dh = (32, 16, 16384, 128)
        assert Hq % Hkv == 0, (Hq, Hkv)
        return {'x': _w((lambda *s: torch.randn(*s, dtype=torch.bfloat16) * 0.1)(B, Sq, D)), 'k_cache': _w((lambda *s: torch.randn(*s, dtype=torch.bfloat16) * 0.8)(B, Hkv, Sk, Dh)), 'v_cache': _w((lambda *s: torch.randn(*s, dtype=torch.bfloat16) * 0.8)(B, Hkv, Sk, Dh)), 'wq': _w((lambda *s: torch.randn(*s, dtype=torch.bfloat16) * 0.8)(D, Hq * Dh) * D ** (-0.5)), 'wo': _w((lambda *s: torch.randn(*s, dtype=torch.bfloat16) * 0.8)(Hq * Dh, D) * (Hq * Dh) ** (-0.5))}
    _A_in = _A_setup()

    def _B_setup():
        B, S, D, F = (2, 1, 576, 4608)
        return {'x': _w((lambda *s: torch.randn(*s, dtype=torch.bfloat16) * 0.1)(B, S, D)), 'w_gate': _w((lambda *s: torch.randn(*s, dtype=torch.bfloat16) * 0.1)(D, F)), 'w_up': _w((lambda *s: torch.randn(*s, dtype=torch.bfloat16) * 0.1)(D, F)), 'w_down': _w((lambda *s: torch.randn(*s, dtype=torch.bfloat16) * 0.1)(F, D))}
    _B_in = _B_setup()
    return {'A_x': _A_in['x'], 'A_k_cache': _A_in['k_cache'], 'A_v_cache': _A_in['v_cache'], 'A_wq': _A_in['wq'], 'A_wo': _A_in['wo'], 'B_x': _B_in['x'], 'B_w_gate': _B_in['w_gate'], 'B_w_up': _B_in['w_up'], 'B_w_down': _B_in['w_down'], 'c': _w((lambda *s: torch.randn(*s, dtype=torch.bfloat16) * 0.4)(2, 576) * 8.0), 'w_mod': _w((lambda *s: torch.randn(*s, dtype=torch.bfloat16) * 0.4)(576, 6 * 576) * 576 ** (-0.5) * 8.0)}

def reference(A_x, A_k_cache, A_v_cache, A_wq, A_wo, B_x, B_w_gate, B_w_up, B_w_down, c, w_mod):

    def _A_ref(x, k_cache, v_cache, wq, wo):
        B, Sq, D = x.shape
        Hq, Dh = (32, 128)
        Hkv = k_cache.shape[1]
        rep = Hq // Hkv
        q = (lambda x, *d: x.permute(*d))((x @ wq).reshape(B, Sq, Hq, Dh), 0, 2, 1, 3)
        k = (lambda x, n, axis: torch.repeat_interleave(x, n, dim=axis))(k_cache, rep, axis=1)
        v = (lambda x, n, axis: torch.repeat_interleave(x, n, dim=axis))(v_cache, rep, axis=1)
        scores = torch.einsum('bhqd,bhkd->bhqk', q, k) * Dh ** (-0.5)
        p = _softmax(scores, axis=-1)
        o = torch.einsum('bhqk,bhkd->bhqd', p, v)
        return (lambda x, *d: x.permute(*d))(o, 0, 2, 1, 3).reshape(B, Sq, Hq * Dh) @ wo

    def _B_ref(x, w_gate, w_up, w_down):
        g = _silu(x @ w_gate)
        u = x @ w_up
        return g * u @ w_down
    x = A_x
    mod = (_silu(c) @ w_mod).reshape(c.shape[0], 6, 1, -1)
    sa, ca, ga, sb, cb, gb = (mod[:, 0].clone(), mod[:, 1].clone(), mod[:, 2].clone(), mod[:, 3].clone(), mod[:, 4].clone(), mod[:, 5].clone())
    h = _layernorm(x, axis=-1) * (1 + ca) + sa
    x = x + ga * _A_ref(h, A_k_cache, A_v_cache, A_wq, A_wo)
    h = _layernorm(x, axis=-1) * (1 + cb) + sb
    x = x + gb * _B_ref(h, B_w_gate, B_w_up, B_w_down)
    return x
```

```asm
; @launch grid=(256,1,1) block=(512,1,1) lds=163840
.amdgcn_target "amdgcn-amd-amdhsa--gfx950"
.text
.globl adaLN_cond__gqa_block_cached__swiglu_ffn__decode_kernel
.p2align 8
.type adaLN_cond__gqa_block_cached__swiglu_ffn__decode_kernel,@function
adaLN_cond__gqa_block_cached__swiglu_ffn__decode_kernel:
s_cmp_ge_u32 s2, 256
s_cbranch_scc1 L_exit
s_load_dwordx16 s[4:19], s[0:1], 0
s_load_dwordx8 s[20:27], s[0:1], 64
s_load_dwordx4 s[28:31], s[0:1], 96
s_getpc_b64 s[68:69]
L_pc0:
s_add_u32 s68, s68, L_tab-L_pc0
s_addc_u32 s69, s69, 0
s_lshl_b32 s70, s2, 2
s_load_dword s67, s[68:69], s70
v_lshrrev_b32 v1, 6, v0
s_nop 0
v_readfirstlane_b32 s3, v1
v_and_b32 v1, 63, v0
s_mov_b32 s73, 0
s_cmp_lt_u32 s3, 4
s_cbranch_scc1 L_streamer
s_setprio 3
s_sub_u32 s47, s3, 4
v_lshrrev_b32 v8, 3, v1
v_and_b32 v9, 7, v1
v_bfe_u32 v10, v1, 4, 1
v_lshlrev_b32 v10, 1, v10
v_xor_b32 v9, v9, v10
v_xor_b32 v12, 4, v9
v_lshlrev_b32 v9, 4, v9
v_lshlrev_b32 v12, 4, v12
v_mov_b32 v14, 0
v_bfe_u32 v10, v1, 3, 1
v_mul_u32_u24 v13, 1152, v10
v_lshrrev_b32 v10, 4, v1
v_lshl_add_u32 v13, v10, 5, v13
v_and_b32 v10, 7, v1
v_lshl_add_u32 v13, v10, 2, v13
s_lshl_b32 s50, s47, 7
v_add_u32 v15, s50, v13
s_waitcnt lgkmcnt(0)
global_load_dword v58, v14, s[30:31] sc1
s_and_b32 s65, s67, 3
s_bfe_u32 s66, s67, 0x80002
s_cmp_eq_u32 s65, 3
s_cbranch_scc1 L_i16
s_cmp_eq_u32 s65, 1
s_cbranch_scc1 L_im
s_cmp_eq_u32 s65, 2
s_cbranch_scc0 L_idone
global_load_dword v19, v15, s[4:5]
global_load_dword v20, v15, s[4:5] offset:512
global_load_dword v21, v13, s[4:5] offset:1024
global_load_dword v22, v13, s[4:5] offset:0
global_load_dword v23, v13, s[4:5] offset:128
global_load_dword v24, v13, s[4:5] offset:256
global_load_dword v25, v13, s[4:5] offset:384
global_load_dword v26, v13, s[4:5] offset:512
global_load_dword v27, v13, s[4:5] offset:640
global_load_dword v28, v13, s[4:5] offset:768
global_load_dword v29, v13, s[4:5] offset:896
global_load_dword v30, v13, s[4:5] offset:1024
s_lshl_b32 s46, s66, 2
s_add_u32 s46, s46, s47
s_and_b32 s50, s46, 14
s_cmp_eq_u32 s50, 0
s_cbranch_scc0 L_i1n
s_and_b32 s50, s46, 1
s_lshl_b32 s50, s50, 4
s_lshr_b32 s51, s46, 4
s_add_u32 s50, s50, s51
s_lshl_b32 s50, s50, 8
s_add_u32 s50, s50, 1572864
v_mov_b32 v10, s50
v_mov_b32 v11, 768
s_mov_b64 exec, 1
global_store_dword v10, v11, s[30:31] sc0 sc1
s_mov_b64 exec, -1
L_i1n:
v_lshl_add_u32 v3, v8, 13, v9
v_lshl_add_u32 v2, v8, 13, v12
s_mov_b32 s32, s10
s_and_b32 s33, s11, 0xffff
s_mov_b32 s34, 4718592
s_mov_b32 s35, 0x20000
s_mul_i32 s50, s47, 262144
s_lshl_b32 s51, s66, 7
s_add_u32 s50, s50, s51
s_mul_i32 s52, s47, 32768
s_add_u32 m0, s52, 0
s_nop 0
buffer_load_dwordx4 v3, s[32:35], s50 offen nt lds
s_add_u32 s50, s50, 65536
s_add_u32 m0, s52, 1024
s_nop 0
buffer_load_dwordx4 v2, s[32:35], s50 offen nt lds
s_add_u32 s50, s50, 65536
s_add_u32 m0, s52, 2048
s_nop 0
buffer_load_dwordx4 v3, s[32:35], s50 offen nt lds
s_add_u32 s50, s50, 65536
s_add_u32 m0, s52, 3072
s_nop 0
buffer_load_dwordx4 v2, s[32:35], s50 offen nt lds
s_add_u32 s50, s50, 851968
s_add_u32 m0, s52, 4096
s_nop 0
buffer_load_dwordx4 v3, s[32:35], s50 offen nt lds
s_add_u32 s50, s50, 65536
s_add_u32 m0, s52, 5120
s_nop 0
buffer_load_dwordx4 v2, s[32:35], s50 offen nt lds
s_add_u32 s50, s50, 65536
s_add_u32 m0, s52, 6144
s_nop 0
buffer_load_dwordx4 v3, s[32:35], s50 offen nt lds
s_add_u32 s50, s50, 65536
s_add_u32 m0, s52, 7168
s_nop 0
buffer_load_dwordx4 v2, s[32:35], s50 offen nt lds
s_add_u32 s50, s50, 851968
s_add_u32 m0, s52, 8192
s_nop 0
buffer_load_dwordx4 v3, s[32:35], s50 offen nt lds
s_add_u32 s50, s50, 65536
s_add_u32 m0, s52, 9216
s_nop 0
buffer_load_dwordx4 v2, s[32:35], s50 offen nt lds
s_add_u32 s50, s50, 65536
s_add_u32 m0, s52, 10240
s_nop 0
buffer_load_dwordx4 v3, s[32:35], s50 offen nt lds
s_add_u32 s50, s50, 65536
s_add_u32 m0, s52, 11264
s_nop 0
buffer_load_dwordx4 v2, s[32:35], s50 offen nt lds
s_add_u32 s50, s50, 851968
s_add_u32 m0, s52, 12288
s_nop 0
buffer_load_dwordx4 v3, s[32:35], s50 offen nt lds
s_add_u32 s50, s50, 65536
s_add_u32 m0, s52, 13312
s_nop 0
buffer_load_dwordx4 v2, s[32:35], s50 offen nt lds
s_add_u32 s50, s50, 65536
s_add_u32 m0, s52, 14336
s_nop 0
buffer_load_dwordx4 v3, s[32:35], s50 offen nt lds
s_add_u32 s50, s50, 65536
s_add_u32 m0, s52, 15360
s_nop 0
buffer_load_dwordx4 v2, s[32:35], s50 offen nt lds
s_add_u32 s50, s50, 851968
s_cmp_ge_u32 s47, 2
s_cbranch_scc1 L_t64i_1
s_add_u32 m0, s52, 16384
s_nop 0
buffer_load_dwordx4 v3, s[32:35], s50 offen nt lds
s_add_u32 s50, s50, 65536
s_add_u32 m0, s52, 17408
s_nop 0
buffer_load_dwordx4 v2, s[32:35], s50 offen nt lds
s_add_u32 s50, s50, 65536
s_add_u32 m0, s52, 18432
s_nop 0
buffer_load_dwordx4 v3, s[32:35], s50 offen nt lds
s_add_u32 s50, s50, 65536
s_add_u32 m0, s52, 19456
s_nop 0
buffer_load_dwordx4 v2, s[32:35], s50 offen nt lds
L_t64i_1:
s_branch L_idone
L_im:
global_load_dword v16, v15, s[22:23]
global_load_dword v17, v15, s[22:23] offset:512
global_load_dword v18, v13, s[22:23] offset:1024
v_mul_u32_u24 v3, 6912, v8
v_add_u32 v2, v3, v12
v_add_u32 v3, v3, v9
s_mov_b32 s32, s24
s_and_b32 s33, s25, 0xffff
s_mov_b32 s34, 3981312
s_mov_b32 s35, 0x20000
s_mul_i32 s50, s47, 221184
s_lshl_b32 s51, s66, 7
s_add_u32 s50, s50, s51
s_mul_i32 s52, s47, 32768
s_add_u32 m0, s52, 0
s_nop 0
buffer_load_dwordx4 v3, s[32:35], s50 offen nt lds
s_add_u32 s50, s50, 55296
s_add_u32 m0, s52, 1024
s_nop 0
buffer_load_dwordx4 v2, s[32:35], s50 offen nt lds
s_add_u32 s50, s50, 55296
s_add_u32 m0, s52, 2048
s_nop 0
buffer_load_dwordx4 v3, s[32:35], s50 offen nt lds
s_add_u32 s50, s50, 55296
s_add_u32 m0, s52, 3072
s_nop 0
buffer_load_dwordx4 v2, s[32:35], s50 offen nt lds
s_add_u32 s50, s50, 718848
s_add_u32 m0, s52, 4096
s_nop 0
buffer_load_dwordx4 v3, s[32:35], s50 offen nt lds
s_add_u32 s50, s50, 55296
s_add_u32 m0, s52, 5120
s_nop 0
buffer_load_dwordx4 v2, s[32:35], s50 offen nt lds
s_add_u32 s50, s50, 55296
s_add_u32 m0, s52, 6144
s_nop 0
buffer_load_dwordx4 v3, s[32:35], s50 offen nt lds
s_add_u32 s50, s50, 55296
s_add_u32 m0, s52, 7168
s_nop 0
buffer_load_dwordx4 v2, s[32:35], s50 offen nt lds
s_add_u32 s50, s50, 718848
s_add_u32 m0, s52, 8192
s_nop 0
buffer_load_dwordx4 v3, s[32:35], s50 offen nt lds
s_add_u32 s50, s50, 55296
s_add_u32 m0, s52, 9216
s_nop 0
buffer_load_dwordx4 v2, s[32:35], s50 offen nt lds
s_add_u32 s50, s50, 55296
s_add_u32 m0, s52, 10240
s_nop 0
buffer_load_dwordx4 v3, s[32:35], s50 offen nt lds
s_add_u32 s50, s50, 55296
s_add_u32 m0, s52, 11264
s_nop 0
buffer_load_dwordx4 v2, s[32:35], s50 offen nt lds
s_add_u32 s50, s50, 718848
s_add_u32 m0, s52, 12288
s_nop 0
buffer_load_dwordx4 v3, s[32:35], s50 offen nt lds
s_add_u32 s50, s50, 55296
s_add_u32 m0, s52, 13312
s_nop 0
buffer_load_dwordx4 v2, s[32:35], s50 offen nt lds
s_add_u32 s50, s50, 55296
s_add_u32 m0, s52, 14336
s_nop 0
buffer_load_dwordx4 v3, s[32:35], s50 offen nt lds
s_add_u32 s50, s50, 55296
s_add_u32 m0, s52, 15360
s_nop 0
buffer_load_dwordx4 v2, s[32:35], s50 offen nt lds
s_add_u32 s50, s50, 718848
s_cmp_ge_u32 s47, 2
s_cbranch_scc1 L_t64i_2
s_add_u32 m0, s52, 16384
s_nop 0
buffer_load_dwordx4 v3, s[32:35], s50 offen nt lds
s_add_u32 s50, s50, 55296
s_add_u32 m0, s52, 17408
s_nop 0
buffer_load_dwordx4 v2, s[32:35], s50 offen nt lds
s_add_u32 s50, s50, 55296
s_add_u32 m0, s52, 18432
s_nop 0
buffer_load_dwordx4 v3, s[32:35], s50 offen nt lds
s_add_u32 s50, s50, 55296
s_add_u32 m0, s52, 19456
s_nop 0
buffer_load_dwordx4 v2, s[32:35], s50 offen nt lds
L_t64i_2:
s_branch L_idone
L_i16:
global_load_dword v16, v15, s[22:23]
global_load_dword v17, v15, s[22:23] offset:512
global_load_dword v18, v13, s[22:23] offset:1024
v_lshrrev_b32 v8, 1, v1
v_mul_u32_u24 v3, 6912, v8
v_and_b32 v8, 1, v1
v_lshl_add_u32 v3, v8, 4, v3
s_mov_b32 s32, s24
s_and_b32 s33, s25, 0xffff
s_mov_b32 s34, 3981312
s_mov_b32 s35, 0x20000
s_mul_i32 s50, s47, 221184
s_lshl_b32 s51, s66, 5
s_add_u32 s50, s50, s51
s_mul_i32 s52, s47, 5120
s_add_u32 s52, s52, 131072
s_add_u32 m0, s52, 0
s_nop 0
buffer_load_dwordx4 v3, s[32:35], s50 offen nt lds
s_add_u32 s50, s50, 884736
s_add_u32 m0, s52, 1024
s_nop 0
buffer_load_dwordx4 v3, s[32:35], s50 offen nt lds
s_add_u32 s50, s50, 884736
s_add_u32 m0, s52, 2048
s_nop 0
buffer_load_dwordx4 v3, s[32:35], s50 offen nt lds
s_add_u32 s50, s50, 884736
s_add_u32 m0, s52, 3072
s_nop 0
buffer_load_dwordx4 v3, s[32:35], s50 offen nt lds
s_add_u32 s50, s50, 884736
s_cmp_ge_u32 s47, 2
s_cbranch_scc1 L_idone
s_add_u32 m0, s52, 4096
s_nop 0
buffer_load_dwordx4 v3, s[32:35], s50 offen nt lds
L_idone:
v_mov_b32 v61, 1
s_cmp_eq_u32 s47, 2
s_cbranch_scc0 L_h_nb
v_mov_b32 v44, 161920
v_mov_b32 v46, 0
v_mov_b32 v47, 0
v_mov_b32 v48, 0
v_mov_b32 v49, 0
s_mov_b64 exec, 1
ds_write_b128 v44, v[46:49]
ds_write_b128 v44, v[46:49] offset:16
ds_write_b128 v44, v[46:49] offset:64
ds_write_b128 v44, v[46:49] offset:80
ds_write_b128 v44, v[46:49] offset:96
ds_write_b128 v44, v[46:49] offset:112
ds_write_b128 v44, v[46:49] offset:128
s_mov_b64 exec, -1
s_waitcnt lgkmcnt(0)
L_h_nb:
s_barrier
v_lshrrev_b32 v8, 4, v1
v_and_b32 v9, 15, v1
v_lshrrev_b32 v10, 2, v9
v_lshl_add_u32 v10, v8, 3, v10
v_and_b32 v11, 3, v9
v_lshlrev_b32 v11, 3, v11
v_lshl_add_u32 v4, v10, 7, v11
s_mul_i32 s50, s47, 32768
v_add_u32 v4, s50, v4
v_bfe_u32 v10, v1, 3, 1
v_bfe_u32 v11, v1, 4, 1
v_lshl_add_u32 v10, v11, 1, v10
v_lshlrev_b32 v10, 5, v10
v_add_u32 v52, v4, v10
v_xor_b32 v11, 32, v10
v_add_u32 v53, v4, v11
v_xor_b32 v11, 64, v10
v_add_u32 v54, v4, v11
v_xor_b32 v11, 96, v10
v_add_u32 v55, v4, v11
v_bfe_u32 v12, v1, 2, 1
v_mul_u32_u24 v5, 1152, v12
v_lshl_add_u32 v5, v8, 4, v5
s_lshl_b32 s50, s47, 6
v_add_u32 v5, s50, v5
s_mul_i32 s50, s47, 5120
s_add_u32 s72, s50, 131072
s_bfe_u32 s49, s67, 0x2000a
s_bfe_u32 s48, s67, 0x8000c
s_cmp_eq_u32 s65, 0
s_cbranch_scc1 L_early
s_cmp_eq_u32 s65, 2
s_cbranch_scc1 L_qcls
s_cmp_eq_u32 s65, 3
s_cbranch_scc1 L_m16
s_cmp_ge_u32 s47, 2
s_cbranch_scc1 L_mw16
s_waitcnt vmcnt(20)
s_branch L_mwd
L_mw16:
s_waitcnt vmcnt(16)
L_mwd:
v_add_u32 v58, 1, v58
s_mov_b32 s54, 0xbfb8aa3b
v_lshlrev_b32 v8, 16, v16
v_and_b32 v9, 0xffff0000, v16
v_mul_f32 v10, s54, v8
v_mul_f32 v11, s54, v9
v_exp_f32 v10, v10
v_exp_f32 v11, v11
v_add_f32 v10, 1.0, v10
v_add_f32 v11, 1.0, v11
v_rcp_f32 v10, v10
v_rcp_f32 v11, v11
v_mul_f32 v8, v8, v10
v_mul_f32 v9, v9, v11
v_cvt_pk_bf16_f32 v16, v8, v9
v_lshlrev_b32 v8, 16, v17
v_and_b32 v9, 0xffff0000, v17
v_mul_f32 v10, s54, v8
v_mul_f32 v11, s54, v9
v_exp_f32 v10, v10
v_exp_f32 v11, v11
v_add_f32 v10, 1.0, v10
v_add_f32 v11, 1.0, v11
v_rcp_f32 v10, v10
v_rcp_f32 v11, v11
v_mul_f32 v8, v8, v10
v_mul_f32 v9, v9, v11
v_cvt_pk_bf16_f32 v17, v8, v9
v_lshlrev_b32 v8, 16, v18
v_and_b32 v9, 0xffff0000, v18
v_mul_f32 v10, s54, v8
v_mul_f32 v11, s54, v9
v_exp_f32 v10, v10
v_exp_f32 v11, v11
v_add_f32 v10, 1.0, v10
v_add_f32 v11, 1.0, v11
v_rcp_f32 v10, v10
v_rcp_f32 v11, v11
v_mul_f32 v8, v8, v10
v_mul_f32 v9, v9, v11
v_cvt_pk_bf16_f32 v18, v8, v9
v_add_u32 v14, 151552, v15
v_add_u32 v12, 151552, v13
ds_write_b32 v14, v16
ds_write_b32 v14, v17 offset:512
ds_write_b32 v12, v18 offset:1024
s_waitcnt lgkmcnt(0)
v_mov_b32 v62, 161928
s_mov_b64 exec, 1
ds_add_u32 v62, v61
s_mov_b64 exec, -1
s_waitcnt vmcnt(0)
ds_read_b64_tr_b16 v[96:97], v52 offset:0
ds_read_b64_tr_b16 v[98:99], v52 offset:512
ds_read_b64_tr_b16 v[100:101], v53 offset:0
ds_read_b64_tr_b16 v[102:103], v53 offset:512
ds_read_b64_tr_b16 v[104:105], v54 offset:0
ds_read_b64_tr_b16 v[106:107], v54 offset:512
ds_read_b64_tr_b16 v[108:109], v55 offset:0
ds_read_b64_tr_b16 v[110:111], v55 offset:512
ds_read_b64_tr_b16 v[112:113], v52 offset:4096
ds_read_b64_tr_b16 v[114:115], v52 offset:4608
ds_read_b64_tr_b16 v[116:117], v53 offset:4096
ds_read_b64_tr_b16 v[118:119], v53 offset:4608
ds_read_b64_tr_b16 v[120:121], v54 offset:4096
ds_read_b64_tr_b16 v[122:123], v54 offset:4608
ds_read_b64_tr_b16 v[124:125], v55 offset:4096
ds_read_b64_tr_b16 v[126:127], v55 offset:4608
ds_read_b64_tr_b16 v[128:129], v52 offset:8192
ds_read_b64_tr_b16 v[130:131], v52 offset:8704
ds_read_b64_tr_b16 v[132:133], v53 offset:8192
ds_read_b64_tr_b16 v[134:135], v53 offset:8704
ds_read_b64_tr_b16 v[136:137], v54 offset:8192
ds_read_b64_tr_b16 v[138:139], v54 offset:8704
ds_read_b64_tr_b16 v[140:141], v55 offset:8192
ds_read_b64_tr_b16 v[142:143], v55 offset:8704
ds_read_b64_tr_b16 v[144:145], v52 offset:12288
ds_read_b64_tr_b16 v[146:147], v52 offset:12800
ds_read_b64_tr_b16 v[148:149], v53 offset:12288
ds_read_b64_tr_b16 v[150:151], v53 offset:12800
ds_read_b64_tr_b16 v[152:153], v54 offset:12288
ds_read_b64_tr_b16 v[154:155], v54 offset:12800
ds_read_b64_tr_b16 v[156:157], v55 offset:12288
ds_read_b64_tr_b16 v[158:159], v55 offset:12800
ds_read_b64_tr_b16 v[160:161], v52 offset:16384
ds_read_b64_tr_b16 v[162:163], v52 offset:16896
ds_read_b64_tr_b16 v[164:165], v53 offset:16384
ds_read_b64_tr_b16 v[166:167], v53 offset:16896
ds_read_b64_tr_b16 v[168:169], v54 offset:16384
ds_read_b64_tr_b16 v[170:171], v54 offset:16896
ds_read_b64_tr_b16 v[172:173], v55 offset:16384
ds_read_b64_tr_b16 v[174:175], v55 offset:16896
v_mov_b32 v63, 161928
L_lw_3:
s_add_u32 s73, s73, 1
s_cmp_gt_u32 s73, 400000
s_movk_i32 s74, 13
s_cbranch_scc1 L_fail
ds_read_b32 v62, v63
s_waitcnt lgkmcnt(0)
v_readfirstlane_b32 s71, v62
s_cmp_ge_u32 s71, 4
s_cbranch_scc0 L_lw_3
v_add_u32 v6, 151552, v5
ds_read_b128 v[32:35], v6 offset:0
ds_read_b128 v[36:39], v6 offset:256
ds_read_b128 v[40:43], v6 offset:512
ds_read_b128 v[44:47], v6 offset:768
ds_read_b128 v[48:51], v6 offset:1024
s_waitcnt lgkmcnt(0)
v_mfma_f32_16x16x32_bf16 v[64:67], v[32:35], v[96:99], 0
v_mfma_f32_16x16x32_bf16 v[68:71], v[32:35], v[100:103], 0
v_mfma_f32_16x16x32_bf16 v[72:75], v[32:35], v[104:107], 0
v_mfma_f32_16x16x32_bf16 v[76:79], v[32:35], v[108:111], 0
v_mfma_f32_16x16x32_bf16 v[64:67], v[36:39], v[112:115], v[64:67]
v_mfma_f32_16x16x32_bf16 v[68:71], v[36:39], v[116:119], v[68:71]
v_mfma_f32_16x16x32_bf16 v[72:75], v[36:39], v[120:123], v[72:75]
v_mfma_f32_16x16x32_bf16 v[76:79], v[36:39], v[124:127], v[76:79]
v_mfma_f32_16x16x32_bf16 v[64:67], v[40:43], v[128:131], v[64:67]
v_mfma_f32_16x16x32_bf16 v[68:71], v[40:43], v[132:135], v[68:71]
v_mfma_f32_16x16x32_bf16 v[72:75], v[40:43], v[136:139], v[72:75]
v_mfma_f32_16x16x32_bf16 v[76:79], v[40:43], v[140:143], v[76:79]
v_mfma_f32_16x16x32_bf16 v[64:67], v[44:47], v[144:147], v[64:67]
v_mfma_f32_16x16x32_bf16 v[68:71], v[44:47], v[148:151], v[68:71]
v_mfma_f32_16x16x32_bf16 v[72:75], v[44:47], v[152:155], v[72:75]
v_mfma_f32_16x16x32_bf16 v[76:79], v[44:47], v[156:159], v[76:79]
s_cmp_ge_u32 s47, 2
s_cbranch_scc1 L_t64m_4
v_mfma_f32_16x16x32_bf16 v[64:67], v[48:51], v[160:163], v[64:67]
v_mfma_f32_16x16x32_bf16 v[68:71], v[48:51], v[164:167], v[68:71]
v_mfma_f32_16x16x32_bf16 v[72:75], v[48:51], v[168:171], v[72:75]
v_mfma_f32_16x16x32_bf16 v[76:79], v[48:51], v[172:175], v[76:79]
L_t64m_4:
v_and_b32 v7, 31, v1
v_lshlrev_b32 v7, 2, v7
s_lshl_b32 s50, s47, 9
s_add_u32 s50, s50, 156672
v_add_u32 v8, s50, v7
s_nop 3
ds_write_b32 v8, v64
ds_write_b32 v8, v68 offset:128
ds_write_b32 v8, v72 offset:256
ds_write_b32 v8, v76 offset:384
s_waitcnt lgkmcnt(0)
v_mov_b32 v62, 161936
s_mov_b64 exec, 1
ds_add_u32 v62, v61
s_mov_b64 exec, -1
s_lshl_b32 s55, s47, 7
s_add_u32 s55, s55, 156672
s_lshl_b32 s53, s66, 2
s_add_u32 s53, s53, s47
v_and_b32 v6, 15, v1
v_lshlrev_b32 v7, 3, v6
v_add_u32 v7, s55, v7
s_lshl_b32 s50, s53, 7
s_add_u32 s50, s50, 4096
v_lshlrev_b32 v6, 3, v6
v_add_u32 v6, s50, v6
v_mov_b32 v11, v58
v_mov_b32 v63, 161936
L_lw_5:
s_add_u32 s73, s73, 1
s_cmp_gt_u32 s73, 400000
s_movk_i32 s74, 17
s_cbranch_scc1 L_fail
ds_read_b32 v62, v63
s_waitcnt lgkmcnt(0)
v_readfirstlane_b32 s71, v62
s_cmp_ge_u32 s71, 4
s_cbranch_scc0 L_lw_5
ds_read_b64 v[16:17], v7 offset:0
ds_read_b64 v[18:19], v7 offset:512
ds_read_b64 v[20:21], v7 offset:1024
ds_read_b64 v[22:23], v7 offset:1536
s_waitcnt lgkmcnt(0)
v_add_f32 v16, v16, v18
v_add_f32 v17, v17, v19
v_add_f32 v20, v20, v22
v_add_f32 v21, v21, v23
v_add_f32 v16, v16, v20
v_add_f32 v17, v17, v21
v_cvt_pk_bf16_f32 v10, v16, v17
s_mov_b64 exec, 0xffff
global_store_dwordx2 v6, v[10:11], s[30:31] sc0 sc1
s_mov_b64 exec, -1
s_waitcnt lgkmcnt(0)
v_mov_b32 v62, 161940
s_mov_b64 exec, 1
ds_add_u32 v62, v61
s_mov_b64 exec, -1
s_branch L_common
L_m16:
s_cmp_ge_u32 s47, 2
s_cbranch_scc1 L_16w4
s_waitcnt vmcnt(5)
s_branch L_16wd
L_16w4:
s_waitcnt vmcnt(4)
L_16wd:
v_add_u32 v58, 1, v58
s_mov_b32 s54, 0xbfb8aa3b
v_lshlrev_b32 v8, 16, v16
v_and_b32 v9, 0xffff0000, v16
v_mul_f32 v10, s54, v8
v_mul_f32 v11, s54, v9
v_exp_f32 v10, v10
v_exp_f32 v11, v11
v_add_f32 v10, 1.0, v10
v_add_f32 v11, 1.0, v11
v_rcp_f32 v10, v10
v_rcp_f32 v11, v11
v_mul_f32 v8, v8, v10
v_mul_f32 v9, v9, v11
v_cvt_pk_bf16_f32 v16, v8, v9
v_lshlrev_b32 v8, 16, v17
v_and_b32 v9, 0xffff0000, v17
v_mul_f32 v10, s54, v8
v_mul_f32 v11, s54, v9
v_exp_f32 v10, v10
v_exp_f32 v11, v11
v_add_f32 v10, 1.0, v10
v_add_f32 v11, 1.0, v11
v_rcp_f32 v10, v10
v_rcp_f32 v11, v11
v_mul_f32 v8, v8, v10
v_mul_f32 v9, v9, v11
v_cvt_pk_bf16_f32 v17, v8, v9
v_lshlrev_b32 v8, 16, v18
v_and_b32 v9, 0xffff0000, v18
v_mul_f32 v10, s54, v8
v_mul_f32 v11, s54, v9
v_exp_f32 v10, v10
v_exp_f32 v11, v11
v_add_f32 v10, 1.0, v10
v_add_f32 v11, 1.0, v11
v_rcp_f32 v10, v10
v_rcp_f32 v11, v11
v_mul_f32 v8, v8, v10
v_mul_f32 v9, v9, v11
v_cvt_pk_bf16_f32 v18, v8, v9
v_add_u32 v14, 151552, v15
v_add_u32 v12, 151552, v13
ds_write_b32 v14, v16
ds_write_b32 v14, v17 offset:512
ds_write_b32 v12, v18 offset:1024
s_waitcnt lgkmcnt(0)
v_mov_b32 v62, 161928
s_mov_b64 exec, 1
ds_add_u32 v62, v61
s_mov_b64 exec, -1
v_lshrrev_b32 v8, 4, v1
v_and_b32 v9, 15, v1
v_lshrrev_b32 v10, 2, v9
v_lshl_add_u32 v10, v8, 3, v10
v_and_b32 v11, 3, v9
v_lshlrev_b32 v11, 3, v11
v_lshl_add_u32 v6, v10, 5, v11
v_add_u32 v6, s72, v6
s_waitcnt vmcnt(0)
ds_read_b64_tr_b16 v[96:97], v6 offset:0
ds_read_b64_tr_b16 v[98:99], v6 offset:128
ds_read_b64_tr_b16 v[100:101], v6 offset:1024
ds_read_b64_tr_b16 v[102:103], v6 offset:1152
ds_read_b64_tr_b16 v[104:105], v6 offset:2048
ds_read_b64_tr_b16 v[106:107], v6 offset:2176
ds_read_b64_tr_b16 v[108:109], v6 offset:3072
ds_read_b64_tr_b16 v[110:111], v6 offset:3200
ds_read_b64_tr_b16 v[112:113], v6 offset:4096
ds_read_b64_tr_b16 v[114:115], v6 offset:4224
v_mov_b32 v63, 161928
L_lw_6:
s_add_u32 s73, s73, 1
s_cmp_gt_u32 s73, 400000
s_movk_i32 s74, 13
s_cbranch_scc1 L_fail
ds_read_b32 v62, v63
s_waitcnt lgkmcnt(0)
v_readfirstlane_b32 s71, v62
s_cmp_ge_u32 s71, 4
s_cbranch_scc0 L_lw_6
v_add_u32 v6, 151552, v5
ds_read_b128 v[32:35], v6 offset:0
ds_read_b128 v[36:39], v6 offset:256
ds_read_b128 v[40:43], v6 offset:512
ds_read_b128 v[44:47], v6 offset:768
ds_read_b128 v[48:51], v6 offset:1024
v_and_b32 v7, 31, v1
v_lshlrev_b32 v7, 2, v7
s_lshl_b32 s50, s47, 7
s_add_u32 s50, s50, 156672
v_add_u32 v8, s50, v7
s_waitcnt lgkmcnt(0)
v_mfma_f32_16x16x32_bf16 v[64:67], v[32:35], v[96:99], 0
v_mfma_f32_16x16x32_bf16 v[64:67], v[36:39], v[100:103], v[64:67]
v_mfma_f32_16x16x32_bf16 v[64:67], v[40:43], v[104:107], v[64:67]
v_mfma_f32_16x16x32_bf16 v[64:67], v[44:47], v[108:111], v[64:67]
s_cmp_ge_u32 s47, 2
s_cbranch_scc1 L_16m
v_mfma_f32_16x16x32_bf16 v[64:67], v[48:51], v[112:115], v[64:67]
L_16m:
s_nop 7
ds_write_b32 v8, v64
s_waitcnt lgkmcnt(0)
v_mov_b32 v62, 161936
s_mov_b64 exec, 1
ds_add_u32 v62, v61
s_mov_b64 exec, -1
s_cmp_eq_u32 s47, 0
s_cbranch_scc0 L_common
s_mov_b32 s55, 156672
v_and_b32 v6, 15, v1
v_lshlrev_b32 v7, 3, v6
v_add_u32 v7, s55, v7
s_lshl_b32 s50, s66, 7
s_add_u32 s50, s50, 1638400
v_lshlrev_b32 v6, 3, v6
v_add_u32 v6, s50, v6
v_lshrrev_b32 v8, 4, v1
v_mul_u32_u24 v8, 9216, v8
v_add_u32 v6, v6, v8
v_mov_b32 v11, v58
v_mov_b32 v63, 161936
L_lw_7:
s_add_u32 s73, s73, 1
s_cmp_gt_u32 s73, 400000
s_movk_i32 s74, 17
s_cbranch_scc1 L_fail
ds_read_b32 v62, v63
s_waitcnt lgkmcnt(0)
v_readfirstlane_b32 s71, v62
s_cmp_ge_u32 s71, 4
s_cbranch_scc0 L_lw_7
ds_read_b64 v[16:17], v7 offset:0
ds_read_b64 v[18:19], v7 offset:128
ds_read_b64 v[20:21], v7 offset:256
ds_read_b64 v[22:23], v7 offset:384
s_waitcnt lgkmcnt(0)
v_add_f32 v16, v16, v18
v_add_f32 v17, v17, v19
v_add_f32 v20, v20, v22
v_add_f32 v21, v21, v23
v_add_f32 v16, v16, v20
v_add_f32 v17, v17, v21
v_cvt_pk_bf16_f32 v10, v16, v17
global_store_dwordx2 v6, v[10:11], s[30:31] sc0 sc1
v_add_u32 v6, 36864, v6
global_store_dwordx2 v6, v[10:11], s[30:31] sc0 sc1
v_mov_b32 v62, 161940
v_mov_b32 v63, 4
s_mov_b64 exec, 1
ds_add_u32 v62, v63
s_mov_b64 exec, -1
s_branch L_common
L_qcls:
s_cmp_ge_u32 s47, 2
s_cbranch_scc1 L_qw16
s_waitcnt vmcnt(20)
s_branch L_qwd
L_qw16:
s_waitcnt vmcnt(16)
L_qwd:
v_add_u32 v58, 1, v58
v_lshlrev_b32 v64, 16, v22
v_and_b32 v65, 0xffff0000, v22
v_lshlrev_b32 v66, 16, v23
v_and_b32 v67, 0xffff0000, v23
v_lshlrev_b32 v68, 16, v24
v_and_b32 v69, 0xffff0000, v24
v_lshlrev_b32 v70, 16, v25
v_and_b32 v71, 0xffff0000, v25
v_lshlrev_b32 v72, 16, v26
v_and_b32 v73, 0xffff0000, v26
v_lshlrev_b32 v74, 16, v27
v_and_b32 v75, 0xffff0000, v27
v_lshlrev_b32 v76, 16, v28
v_and_b32 v77, 0xffff0000, v28
v_lshlrev_b32 v78, 16, v29
v_and_b32 v79, 0xffff0000, v29
v_lshlrev_b32 v80, 16, v30
v_and_b32 v81, 0xffff0000, v30
v_add_f32 v8, v64, v65
v_add_f32 v8, v8, v66
v_add_f32 v8, v8, v67
v_add_f32 v8, v8, v68
v_add_f32 v8, v8, v69
v_add_f32 v8, v8, v70
v_add_f32 v8, v8, v71
v_add_f32 v8, v8, v72
v_add_f32 v8, v8, v73
v_add_f32 v8, v8, v74
v_add_f32 v8, v8, v75
v_add_f32 v8, v8, v76
v_add_f32 v8, v8, v77
v_add_f32 v8, v8, v78
v_add_f32 v8, v8, v79
v_add_f32 v8, v8, v80
v_add_f32 v8, v8, v81
s_nop 1
v_add_f32_dpp v8, v8, v8 quad_perm:[1,0,3,2] row_mask:0xf bank_mask:0xf
s_nop 1
v_add_f32_dpp v8, v8, v8 quad_perm:[2,3,0,1] row_mask:0xf bank_mask:0xf
s_nop 1
v_add_f32_dpp v8, v8, v8 row_half_mirror row_mask:0xf bank_mask:0xf
v_mov_b32 v9, v8
s_nop 1
v_permlane16_swap_b32 v9, v8
v_add_f32 v8, v8, v9
v_mov_b32 v9, v8
s_nop 1
v_permlane32_swap_b32 v9, v8
v_add_f32 v8, v8, v9
v_mul_f32 v8, 0x3ae38e39, v8
v_sub_f32 v10, v64, v8
v_mul_f32 v11, v10, v10
v_sub_f32 v10, v65, v8
v_fmac_f32 v11, v10, v10
v_sub_f32 v10, v66, v8
v_fmac_f32 v11, v10, v10
v_sub_f32 v10, v67, v8
v_fmac_f32 v11, v10, v10
v_sub_f32 v10, v68, v8
v_fmac_f32 v11, v10, v10
v_sub_f32 v10, v69, v8
v_fmac_f32 v11, v10, v10
v_sub_f32 v10, v70, v8
v_fmac_f32 v11, v10, v10
v_sub_f32 v10, v71, v8
v_fmac_f32 v11, v10, v10
v_sub_f32 v10, v72, v8
v_fmac_f32 v11, v10, v10
v_sub_f32 v10, v73, v8
v_fmac_f32 v11, v10, v10
v_sub_f32 v10, v74, v8
v_fmac_f32 v11, v10, v10
v_sub_f32 v10, v75, v8
v_fmac_f32 v11, v10, v10
v_sub_f32 v10, v76, v8
v_fmac_f32 v11, v10, v10
v_sub_f32 v10, v77, v8
v_fmac_f32 v11, v10, v10
v_sub_f32 v10, v78, v8
v_fmac_f32 v11, v10, v10
v_sub_f32 v10, v79, v8
v_fmac_f32 v11, v10, v10
v_sub_f32 v10, v80, v8
v_fmac_f32 v11, v10, v10
v_sub_f32 v10, v81, v8
v_fmac_f32 v11, v10, v10
s_nop 1
v_add_f32_dpp v11, v11, v11 quad_perm:[1,0,3,2] row_mask:0xf bank_mask:0xf
s_nop 1
v_add_f32_dpp v11, v11, v11 quad_perm:[2,3,0,1] row_mask:0xf bank_mask:0xf
s_nop 1
v_add_f32_dpp v11, v11, v11 row_half_mirror row_mask:0xf bank_mask:0xf
v_mov_b32 v9, v11
s_nop 1
v_permlane16_swap_b32 v9, v11
v_add_f32 v11, v11, v9
v_mov_b32 v9, v11
s_nop 1
v_permlane32_swap_b32 v9, v11
v_add_f32 v11, v11, v9
v_mul_f32 v11, 0x3ae38e39, v11
v_cvt_pk_bf16_f32 v9, v8, v8
v_lshlrev_b32 v8, 16, v9
v_cvt_pk_bf16_f32 v9, v11, v11
v_lshlrev_b32 v11, 16, v9
v_add_f32 v11, 0x3727c5ac, v11
v_cvt_pk_bf16_f32 v9, v11, v11
v_lshlrev_b32 v11, 16, v9
v_sqrt_f32 v11, v11
s_nop 0
v_cvt_pk_bf16_f32 v9, v11, v11
v_lshlrev_b32 v11, 16, v9
v_rcp_f32 v11, v11
v_lshlrev_b32 v80, 16, v19
v_and_b32 v81, 0xffff0000, v19
v_sub_f32 v80, v80, v8
v_sub_f32 v81, v81, v8
v_cvt_pk_bf16_f32 v9, v80, v81
v_lshlrev_b32 v80, 16, v9
v_and_b32 v81, 0xffff0000, v9
v_mul_f32 v80, v80, v11
v_mul_f32 v81, v81, v11
v_cvt_pk_bf16_f32 v9, v80, v81
v_lshlrev_b32 v80, 16, v9
v_and_b32 v81, 0xffff0000, v9
v_lshlrev_b32 v82, 16, v20
v_and_b32 v83, 0xffff0000, v20
v_sub_f32 v82, v82, v8
v_sub_f32 v83, v83, v8
v_cvt_pk_bf16_f32 v9, v82, v83
v_lshlrev_b32 v82, 16, v9
v_and_b32 v83, 0xffff0000, v9
v_mul_f32 v82, v82, v11
v_mul_f32 v83, v83, v11
v_cvt_pk_bf16_f32 v9, v82, v83
v_lshlrev_b32 v82, 16, v9
v_and_b32 v83, 0xffff0000, v9
v_lshlrev_b32 v84, 16, v21
v_and_b32 v85, 0xffff0000, v21
v_sub_f32 v84, v84, v8
v_sub_f32 v85, v85, v8
v_cvt_pk_bf16_f32 v9, v84, v85
v_lshlrev_b32 v84, 16, v9
v_and_b32 v85, 0xffff0000, v9
v_mul_f32 v84, v84, v11
v_mul_f32 v85, v85, v11
v_cvt_pk_bf16_f32 v9, v84, v85
v_lshlrev_b32 v84, 16, v9
v_and_b32 v85, 0xffff0000, v9
s_waitcnt vmcnt(0)
ds_read_b64_tr_b16 v[96:97], v52 offset:0
ds_read_b64_tr_b16 v[98:99], v52 offset:512
ds_read_b64_tr_b16 v[100:101], v53 offset:0
ds_read_b64_tr_b16 v[102:103], v53 offset:512
ds_read_b64_tr_b16 v[104:105], v54 offset:0
ds_read_b64_tr_b16 v[106:107], v54 offset:512
ds_read_b64_tr_b16 v[108:109], v55 offset:0
ds_read_b64_tr_b16 v[110:111], v55 offset:512
ds_read_b64_tr_b16 v[112:113], v52 offset:4096
ds_read_b64_tr_b16 v[114:115], v52 offset:4608
ds_read_b64_tr_b16 v[116:117], v53 offset:4096
ds_read_b64_tr_b16 v[118:119], v53 offset:4608
ds_read_b64_tr_b16 v[120:121], v54 offset:4096
ds_read_b64_tr_b16 v[122:123], v54 offset:4608
ds_read_b64_tr_b16 v[124:125], v55 offset:4096
ds_read_b64_tr_b16 v[126:127], v55 offset:4608
ds_read_b64_tr_b16 v[128:129], v52 offset:8192
ds_read_b64_tr_b16 v[130:131], v52 offset:8704
ds_read_b64_tr_b16 v[132:133], v53 offset:8192
ds_read_b64_tr_b16 v[134:135], v53 offset:8704
ds_read_b64_tr_b16 v[136:137], v54 offset:8192
ds_read_b64_tr_b16 v[138:139], v54 offset:8704
ds_read_b64_tr_b16 v[140:141], v55 offset:8192
ds_read_b64_tr_b16 v[142:143], v55 offset:8704
ds_read_b64_tr_b16 v[144:145], v52 offset:12288
ds_read_b64_tr_b16 v[146:147], v52 offset:12800
ds_read_b64_tr_b16 v[148:149], v53 offset:12288
ds_read_b64_tr_b16 v[150:151], v53 offset:12800
ds_read_b64_tr_b16 v[152:153], v54 offset:12288
ds_read_b64_tr_b16 v[154:155], v54 offset:12800
ds_read_b64_tr_b16 v[156:157], v55 offset:12288
ds_read_b64_tr_b16 v[158:159], v55 offset:12800
ds_read_b64_tr_b16 v[160:161], v52 offset:16384
ds_read_b64_tr_b16 v[162:163], v52 offset:16896
ds_read_b64_tr_b16 v[164:165], v53 offset:16384
ds_read_b64_tr_b16 v[166:167], v53 offset:16896
ds_read_b64_tr_b16 v[168:169], v54 offset:16384
ds_read_b64_tr_b16 v[170:171], v54 offset:16896
ds_read_b64_tr_b16 v[172:173], v55 offset:16384
ds_read_b64_tr_b16 v[174:175], v55 offset:16896
v_lshlrev_b32 v14, 3, v1
s_and_b32 s51, s2, 7
s_mul_i32 s51, s51, 9216
s_add_u32 s51, s51, 1638400
s_lshl_b32 s50, s47, 9
s_add_u32 s50, s50, s51
v_add_u32 v15, s50, v14
s_add_u32 s51, s51, 4096
v_add_u32 v14, s51, v14
v_add_u32 v16, 4608, v15
v_add_u32 v17, 4608, v14
L_hop1_8:
global_load_dwordx2 v[18:19], v15, s[30:31] sc1
global_load_dwordx2 v[20:21], v15, s[30:31] offset:2048 sc1
global_load_dwordx2 v[22:23], v14, s[30:31] sc1
global_load_dwordx2 v[24:25], v16, s[30:31] sc1
global_load_dwordx2 v[26:27], v16, s[30:31] offset:2048 sc1
global_load_dwordx2 v[28:29], v17, s[30:31] sc1
s_waitcnt vmcnt(0)
s_mov_b64 s[52:53], 0
v_cmp_ne_u32 vcc, v19, v58
s_or_b64 s[52:53], s[52:53], vcc
v_cmp_ne_u32 vcc, v21, v58
s_or_b64 s[52:53], s[52:53], vcc
v_cmp_ne_u32 vcc, v23, v58
s_or_b64 s[52:53], s[52:53], vcc
v_cmp_ne_u32 vcc, v25, v58
s_or_b64 s[52:53], s[52:53], vcc
v_cmp_ne_u32 vcc, v27, v58
s_or_b64 s[52:53], s[52:53], vcc
v_cmp_ne_u32 vcc, v29, v58
s_or_b64 s[52:53], s[52:53], vcc
s_add_u32 s73, s73, 1
s_cmp_gt_u32 s73, 400000
s_movk_i32 s74, 5
s_cbranch_scc1 L_fail
s_cmp_lg_u64 s[52:53], 0
s_cbranch_scc1 L_hop1_8
v_lshlrev_b32 v8, 16, v24
v_and_b32 v9, 0xffff0000, v24
v_add_f32 v8, 1.0, v8
v_add_f32 v9, 1.0, v9
v_cvt_pk_bf16_f32 v10, v8, v9
v_lshlrev_b32 v8, 16, v10
v_and_b32 v9, 0xffff0000, v10
v_mul_f32 v8, v80, v8
v_mul_f32 v9, v81, v9
v_cvt_pk_bf16_f32 v10, v8, v9
v_lshlrev_b32 v8, 16, v10
v_and_b32 v9, 0xffff0000, v10
v_lshlrev_b32 v10, 16, v18
v_and_b32 v11, 0xffff0000, v18
v_add_f32 v8, v8, v10
v_add_f32 v9, v9, v11
v_cvt_pk_bf16_f32 v86, v8, v9
v_lshlrev_b32 v8, 16, v26
v_and_b32 v9, 0xffff0000, v26
v_add_f32 v8, 1.0, v8
v_add_f32 v9, 1.0, v9
v_cvt_pk_bf16_f32 v10, v8, v9
v_lshlrev_b32 v8, 16, v10
v_and_b32 v9, 0xffff0000, v10
v_mul_f32 v8, v82, v8
v_mul_f32 v9, v83, v9
v_cvt_pk_bf16_f32 v10, v8, v9
v_lshlrev_b32 v8, 16, v10
v_and_b32 v9, 0xffff0000, v10
v_lshlrev_b32 v10, 16, v20
v_and_b32 v11, 0xffff0000, v20
v_add_f32 v8, v8, v10
v_add_f32 v9, v9, v11
v_cvt_pk_bf16_f32 v87, v8, v9
v_lshlrev_b32 v8, 16, v28
v_and_b32 v9, 0xffff0000, v28
v_add_f32 v8, 1.0, v8
v_add_f32 v9, 1.0, v9
v_cvt_pk_bf16_f32 v10, v8, v9
v_lshlrev_b32 v8, 16, v10
v_and_b32 v9, 0xffff0000, v10
v_mul_f32 v8, v84, v8
v_mul_f32 v9, v85, v9
v_cvt_pk_bf16_f32 v10, v8, v9
v_lshlrev_b32 v8, 16, v10
v_and_b32 v9, 0xffff0000, v10
v_lshlrev_b32 v10, 16, v22
v_and_b32 v11, 0xffff0000, v22
v_add_f32 v8, v8, v10
v_add_f32 v9, v9, v11
v_cvt_pk_bf16_f32 v88, v8, v9
s_lshl_b32 s50, s47, 7
s_add_u32 s50, s50, 153856
v_add_u32 v14, s50, v13
v_add_u32 v12, 153856, v13
ds_write_b32 v14, v86
ds_write_b32 v14, v87 offset:512
ds_write_b32 v12, v88 offset:1024
s_waitcnt lgkmcnt(0)
v_mov_b32 v62, 161932
s_mov_b64 exec, 1
ds_add_u32 v62, v61
s_mov_b64 exec, -1
v_mov_b32 v63, 161932
L_lw_9:
s_add_u32 s73, s73, 1
s_cmp_gt_u32 s73, 400000
s_movk_i32 s74, 14
s_cbranch_scc1 L_fail
ds_read_b32 v62, v63
s_waitcnt lgkmcnt(0)
v_readfirstlane_b32 s71, v62
s_cmp_ge_u32 s71, 4
s_cbranch_scc0 L_lw_9
v_add_u32 v6, 153856, v5
ds_read_b128 v[32:35], v6 offset:0
ds_read_b128 v[36:39], v6 offset:256
ds_read_b128 v[40:43], v6 offset:512
ds_read_b128 v[44:47], v6 offset:768
ds_read_b128 v[48:51], v6 offset:1024
s_waitcnt lgkmcnt(0)
v_mfma_f32_16x16x32_bf16 v[64:67], v[32:35], v[96:99], 0
v_mfma_f32_16x16x32_bf16 v[68:71], v[32:35], v[100:103], 0
v_mfma_f32_16x16x32_bf16 v[72:75], v[32:35], v[104:107], 0
v_mfma_f32_16x16x32_bf16 v[76:79], v[32:35], v[108:111], 0
v_mfma_f32_16x16x32_bf16 v[64:67], v[36:39], v[112:115], v[64:67]
v_mfma_f32_16x16x32_bf16 v[68:71], v[36:39], v[116:119], v[68:71]
v_mfma_f32_16x16x32_bf16 v[72:75], v[36:39], v[120:123], v[72:75]
v_mfma_f32_16x16x32_bf16 v[76:79], v[36:39], v[124:127], v[76:79]
v_mfma_f32_16x16x32_bf16 v[64:67], v[40:43], v[128:131], v[64:67]
v_mfma_f32_16x16x32_bf16 v[68:71], v[40:43], v[132:135], v[68:71]
v_mfma_f32_16x16x32_bf16 v[72:75], v[40:43], v[136:139], v[72:75]
v_mfma_f32_16x16x32_bf16 v[76:79], v[40:43], v[140:143], v[76:79]
v_mfma_f32_16x16x32_bf16 v[64:67], v[44:47], v[144:147], v[64:67]
v_mfma_f32_16x16x32_bf16 v[68:71], v[44:47], v[148:151], v[68:71]
v_mfma_f32_16x16x32_bf16 v[72:75], v[44:47], v[152:155], v[72:75]
v_mfma_f32_16x16x32_bf16 v[76:79], v[44:47], v[156:159], v[76:79]
s_cmp_ge_u32 s47, 2
s_cbranch_scc1 L_t64m_10
v_mfma_f32_16x16x32_bf16 v[64:67], v[48:51], v[160:163], v[64:67]
v_mfma_f32_16x16x32_bf16 v[68:71], v[48:51], v[164:167], v[68:71]
v_mfma_f32_16x16x32_bf16 v[72:75], v[48:51], v[168:171], v[72:75]
v_mfma_f32_16x16x32_bf16 v[76:79], v[48:51], v[172:175], v[76:79]
L_t64m_10:
v_and_b32 v7, 31, v1
v_lshlrev_b32 v7, 2, v7
s_lshl_b32 s50, s47, 9
s_add_u32 s50, s50, 156672
v_add_u32 v8, s50, v7
s_nop 3
ds_write_b32 v8, v64
ds_write_b32 v8, v68 offset:128
ds_write_b32 v8, v72 offset:256
ds_write_b32 v8, v76 offset:384
s_waitcnt lgkmcnt(0)
v_mov_b32 v62, 161936
s_mov_b64 exec, 1
ds_add_u32 v62, v61
s_mov_b64 exec, -1
s_lshl_b32 s55, s47, 7
s_add_u32 s55, s55, 156672
s_lshl_b32 s53, s66, 2
s_add_u32 s53, s53, s47
v_and_b32 v6, 15, v1
v_lshlrev_b32 v7, 3, v6
v_add_u32 v7, s55, v7
s_lshl_b32 s50, s53, 7
s_add_u32 s50, s50, 1769472
v_lshlrev_b32 v6, 3, v6
v_add_u32 v6, s50, v6
v_lshrrev_b32 v8, 4, v1
v_mul_u32_u24 v8, 32768, v8
v_add_u32 v6, v6, v8
v_mov_b32 v11, v58
v_mov_b32 v63, 161936
L_lw_11:
s_add_u32 s73, s73, 1
s_cmp_gt_u32 s73, 400000
s_movk_i32 s74, 17
s_cbranch_scc1 L_fail
ds_read_b32 v62, v63
s_waitcnt lgkmcnt(0)
v_readfirstlane_b32 s71, v62
s_cmp_ge_u32 s71, 4
s_cbranch_scc0 L_lw_11
ds_read_b64 v[16:17], v7 offset:0
ds_read_b64 v[18:19], v7 offset:512
ds_read_b64 v[20:21], v7 offset:1024
ds_read_b64 v[22:23], v7 offset:1536
s_waitcnt lgkmcnt(0)
v_add_f32 v16, v16, v18
v_add_f32 v17, v17, v19
v_add_f32 v20, v20, v22
v_add_f32 v21, v21, v23
v_add_f32 v16, v16, v20
v_add_f32 v17, v17, v21
v_cvt_pk_bf16_f32 v10, v16, v17
global_store_dwordx2 v6, v[10:11], s[30:31] sc0 sc1
v_add_u32 v6, 131072, v6
global_store_dwordx2 v6, v[10:11], s[30:31] sc0 sc1
s_waitcnt lgkmcnt(0)
v_mov_b32 v62, 161940
s_mov_b64 exec, 1
ds_add_u32 v62, v61
s_mov_b64 exec, -1
s_branch L_common
L_early:
s_waitcnt vmcnt(0)
v_add_u32 v58, 1, v58
L_common:
s_cmp_eq_u32 s47, 3
s_cbranch_scc0 L_h_s4
v_mov_b32 v40, -1
v_mov_b32 v41, -1
v_mov_b32 v42, -1
v_mov_b32 v43, -1
v_lshlrev_b32 v44, 4, v1
s_bfe_u32 s50, s67, 0x50014
s_lshl_b32 s50, s50, 3
s_and_b32 s51, s2, 7
s_add_u32 s50, s50, s51
s_mul_i32 s50, s50, 1152
s_add_u32 s50, s50, 131072
v_add_u32 v45, s50, v44
global_store_dwordx4 v45, v[40:43], s[30:31] sc0 sc1
s_mov_b64 exec, 0xff
global_store_dwordx4 v45, v[40:43], s[30:31] offset:1024 sc0 sc1
s_mov_b64 exec, -1
s_cmp_eq_u32 s49, 3
s_cbranch_scc0 L_h_s2
s_lshl_b32 s50, s48, 7
s_add_u32 s50, s50, 786432
v_lshrrev_b32 v45, 3, v1
v_mul_u32_u24 v45, 4608, v45
v_and_b32 v46, 7, v1
v_lshl_add_u32 v45, v46, 4, v45
v_add_u32 v45, s50, v45
global_store_dwordx4 v45, v[40:43], s[30:31] sc0 sc1
s_branch L_h_s3
L_h_s2:
s_cmp_eq_u32 s49, 0
s_cbranch_scc1 L_h_s3
s_mov_b32 s51, 851968
s_cmp_eq_u32 s49, 2
s_cselect_b32 s51, 458752, s51
s_mul_i32 s50, s48, 4608
s_add_u32 s50, s50, s51
v_add_u32 v45, s50, v44
global_store_dwordx4 v45, v[40:43], s[30:31] sc0 sc1
global_store_dwordx4 v45, v[40:43], s[30:31] offset:1024 sc0 sc1
global_store_dwordx4 v45, v[40:43], s[30:31] offset:2048 sc0 sc1
global_store_dwordx4 v45, v[40:43], s[30:31] offset:3072 sc0 sc1
v_add_u32 v45, 4096, v45
s_mov_b32 s50, -1
s_mov_b32 s51, 0
s_mov_b64 exec, s[50:51]
global_store_dwordx4 v45, v[40:43], s[30:31] sc0 sc1
s_mov_b64 exec, -1
L_h_s3:
s_waitcnt vmcnt(0)
s_mov_b64 exec, 1
v_mov_b32 v14, 0
global_atomic_add v14, v61, s[28:29] sc1
s_mov_b64 exec, -1
L_h_s4:
L_hop2:
s_cmp_eq_u32 s47, 2
s_cbranch_scc0 L_h_nq
s_bfe_u32 s50, s67, 0x50014
s_and_b32 s51, s50, 15
s_lshr_b32 s50, s50, 4
s_lshl_b32 s51, s51, 11
s_lshl_b32 s50, s50, 6
s_add_u32 s50, s50, s51
s_and_b32 s51, s2, 7
s_lshl_b32 s51, s51, 15
s_add_u32 s50, s50, s51
s_add_u32 s50, s50, 1769472
v_lshrrev_b32 v14, 2, v1
v_lshlrev_b32 v14, 7, v14
v_and_b32 v15, 3, v1
v_lshl_add_u32 v14, v15, 4, v14
v_add_u32 v14, s50, v14
s_mov_b32 s75, 0
L_hop2_12:
global_load_dwordx4 v[16:19], v14, s[30:31] sc1
s_waitcnt vmcnt(0)
s_cmp_eq_u32 s65, 0
s_cbranch_scc0 L_eg_13
s_add_u32 s75, s75, 1
s_cmp_eq_u32 s75, 2
s_cbranch_scc0 L_eg_13
v_mov_b32 v62, 161940
v_mov_b32 v63, 4
s_mov_b64 exec, 1
ds_add_u32 v62, v63
s_mov_b64 exec, -1
L_eg_13:
v_cmp_ne_u32 vcc, v17, v58
s_mov_b64 s[52:53], vcc
v_cmp_ne_u32 vcc, v19, v58
s_or_b64 s[52:53], s[52:53], vcc
s_add_u32 s73, s73, 1
s_cmp_gt_u32 s73, 400000
s_movk_i32 s74, 6
s_cbranch_scc1 L_fail
s_cmp_lg_u64 s[52:53], 0
s_cbranch_scc1 L_hop2_12
v_mov_b32 v17, v18
v_lshlrev_b32 v14, 3, v1
v_add_u32 v14, 156160, v14
ds_write_b64 v14, v[16:17]
s_waitcnt lgkmcnt(0)
v_mov_b32 v14, 161924
s_mov_b64 exec, 1
ds_write_b32 v14, v61
v_mov_b32 v62, 161940
v_mov_b32 v63, 4
ds_add_u32 v62, v63
s_mov_b64 exec, -1
L_h_nq:
v_mov_b32 v63, 161924
L_lw_14:
s_add_u32 s73, s73, 1
s_cmp_gt_u32 s73, 400000
s_movk_i32 s74, 16
s_cbranch_scc1 L_fail
ds_read_b32 v62, v63
s_waitcnt lgkmcnt(0)
v_readfirstlane_b32 s71, v62
s_cmp_ge_u32 s71, 1
s_cbranch_scc0 L_lw_14
s_cmp_eq_u32 s49, 1
s_cbranch_scc1 L_ffn_issue2
s_cmp_eq_u32 s49, 2
s_cbranch_scc1 L_wo_issue2
L_postissue:
s_cmp_eq_u32 s49, 1
s_cbranch_scc1 L_ffn
s_cmp_eq_u32 s49, 2
s_cbranch_scc1 L_wo
s_cmp_eq_u32 s49, 3
s_cbranch_scc1 L_red
s_barrier
s_branch L_hdone
L_wo_issue2:
s_mov_b32 s32, s12
s_and_b32 s33, s13, 0xffff
s_mov_b32 s34, 4718592
s_mov_b32 s35, 0x20000
v_lshrrev_b32 v8, 3, v1
v_mul_u32_u24 v6, 1152, v8
v_and_b32 v8, 7, v1
v_lshl_add_u32 v6, v8, 4, v6
v_lshrrev_b32 v8, 4, v1
v_and_b32 v9, 15, v1
v_lshrrev_b32 v10, 2, v9
v_lshl_add_u32 v10, v8, 3, v10
v_lshlrev_b32 v7, 7, v10
v_and_b32 v11, 3, v9
v_lshl_add_u32 v7, v11, 3, v7
v_add_u32 v7, s72, v7
v_lshlrev_b32 v59, 4, v1
v_add_u32 v59, s72, v59
s_mul_i32 s50, s48, 73728
s_lshl_b32 s55, s47, 7
s_add_u32 s50, s50, s55
s_add_u32 s54, s50, 0
s_mov_b32 s51, s54
buffer_load_dwordx4 v[96:99], v6, s[32:35], s51 offen nt
s_add_u32 s51, s51, 9216
buffer_load_dwordx4 v[100:103], v6, s[32:35], s51 offen nt
s_add_u32 s51, s51, 9216
buffer_load_dwordx4 v[104:107], v6, s[32:35], s51 offen nt
s_add_u32 s51, s51, 9216
buffer_load_dwordx4 v[108:111], v6, s[32:35], s51 offen nt
s_mul_i32 s50, s48, 73728
s_lshl_b32 s55, s47, 7
s_add_u32 s50, s50, s55
s_add_u32 s54, s50, 36864
s_mov_b32 s51, s54
buffer_load_dwordx4 v[112:115], v6, s[32:35], s51 offen nt
s_add_u32 s51, s51, 9216
buffer_load_dwordx4 v[116:119], v6, s[32:35], s51 offen nt
s_add_u32 s51, s51, 9216
buffer_load_dwordx4 v[120:123], v6, s[32:35], s51 offen nt
s_add_u32 s51, s51, 9216
buffer_load_dwordx4 v[124:127], v6, s[32:35], s51 offen nt
s_waitcnt vmcnt(4)
L_wo_sk_15:
s_mul_i32 s50, s48, 73728
s_lshl_b32 s55, s47, 7
s_add_u32 s50, s50, s55
s_add_u32 s54, s50, 512
s_mov_b32 s51, s54
buffer_load_dwordx4 v[128:131], v6, s[32:35], s51 offen nt
s_add_u32 s51, s51, 9216
buffer_load_dwordx4 v[132:135], v6, s[32:35], s51 offen nt
s_add_u32 s51, s51, 9216
buffer_load_dwordx4 v[136:139], v6, s[32:35], s51 offen nt
s_add_u32 s51, s51, 9216
buffer_load_dwordx4 v[140:143], v6, s[32:35], s51 offen nt
s_waitcnt vmcnt(4)
s_mul_i32 s50, s48, 73728
s_lshl_b32 s55, s47, 7
s_add_u32 s50, s50, s55
s_add_u32 s54, s50, 37376
s_mov_b32 s51, s54
buffer_load_dwordx4 v[144:147], v6, s[32:35], s51 offen nt
s_add_u32 s51, s51, 9216
buffer_load_dwordx4 v[148:151], v6, s[32:35], s51 offen nt
s_add_u32 s51, s51, 9216
buffer_load_dwordx4 v[152:155], v6, s[32:35], s51 offen nt
s_add_u32 s51, s51, 9216
buffer_load_dwordx4 v[156:159], v6, s[32:35], s51 offen nt
s_waitcnt vmcnt(4)
L_wo_sk_16:
s_cmp_lg_u32 s47, 0
s_cbranch_scc1 L_wo_sk_17
s_mul_i32 s50, s48, 73728
s_lshl_b32 s55, s47, 7
s_add_u32 s50, s50, s55
s_add_u32 s54, s50, 1024
s_mov_b32 s51, s54
buffer_load_dwordx4 v[160:163], v6, s[32:35], s51 offen nt
s_add_u32 s51, s51, 9216
buffer_load_dwordx4 v[164:167], v6, s[32:35], s51 offen nt
s_add_u32 s51, s51, 9216
buffer_load_dwordx4 v[168:171], v6, s[32:35], s51 offen nt
s_add_u32 s51, s51, 9216
buffer_load_dwordx4 v[172:175], v6, s[32:35], s51 offen nt
s_waitcnt vmcnt(4)
s_mul_i32 s50, s48, 73728
s_lshl_b32 s55, s47, 7
s_add_u32 s50, s50, s55
s_add_u32 s54, s50, 37888
s_mov_b32 s51, s54
buffer_load_dwordx4 v[176:179], v6, s[32:35], s51 offen nt
s_add_u32 s51, s51, 9216
buffer_load_dwordx4 v[180:183], v6, s[32:35], s51 offen nt
s_add_u32 s51, s51, 9216
buffer_load_dwordx4 v[184:187], v6, s[32:35], s51 offen nt
s_add_u32 s51, s51, 9216
buffer_load_dwordx4 v[188:191], v6, s[32:35], s51 offen nt
s_waitcnt vmcnt(4)
L_wo_sk_17:
s_branch L_postissue
L_ffn_issue2:
s_mov_b32 s32, s16
s_and_b32 s33, s17, 0xffff
s_mov_b32 s34, 5308416
s_mov_b32 s35, 0x20000
s_mov_b32 s36, s18
s_and_b32 s37, s19, 0xffff
s_mov_b32 s38, 5308416
s_mov_b32 s39, 0x20000
s_mov_b32 s40, s20
s_and_b32 s41, s21, 0xffff
s_mov_b32 s42, 5308416
s_mov_b32 s43, 0x20000
v_lshrrev_b32 v8, 2, v1
v_mul_u32_u24 v248, 9216, v8
v_and_b32 v8, 3, v1
v_lshl_add_u32 v248, v8, 4, v248
v_lshrrev_b32 v8, 3, v1
v_mul_u32_u24 v249, 1152, v8
v_and_b32 v8, 7, v1
v_lshl_add_u32 v249, v8, 4, v249
v_lshrrev_b32 v8, 4, v1
v_and_b32 v9, 15, v1
v_lshrrev_b32 v10, 2, v9
v_lshl_add_u32 v10, v8, 3, v10
v_and_b32 v11, 3, v9
v_lshlrev_b32 v11, 3, v11
v_lshl_add_u32 v250, v10, 6, v11
v_add_u32 v250, s72, v250
v_lshl_add_u32 v251, v10, 7, v11
v_add_u32 v251, s72, v251
v_lshlrev_b32 v252, 4, v1
v_add_u32 v252, s72, v252
s_add_u32 s50, s47, 0
s_mul_i32 s50, s50, 294912
s_lshl_b32 s51, s48, 6
s_add_u32 s50, s50, s51
s_add_u32 s51, s50, 147456
buffer_load_dwordx4 v[96:99], v248, s[32:35], s50 offen
buffer_load_dwordx4 v[100:103], v248, s[32:35], s51 offen
L_ffn_sk_18:
s_add_u32 s50, s47, 4
s_mul_i32 s50, s50, 294912
s_lshl_b32 s51, s48, 6
s_add_u32 s50, s50, s51
s_add_u32 s51, s50, 147456
buffer_load_dwordx4 v[112:115], v248, s[32:35], s50 offen
buffer_load_dwordx4 v[116:119], v248, s[32:35], s51 offen
L_ffn_sk_19:
s_add_u32 s50, s47, 8
s_mul_i32 s50, s50, 294912
s_lshl_b32 s51, s48, 6
s_add_u32 s50, s50, s51
s_add_u32 s51, s50, 147456
buffer_load_dwordx4 v[128:131], v248, s[32:35], s50 offen
buffer_load_dwordx4 v[132:135], v248, s[32:35], s51 offen
L_ffn_sk_20:
s_add_u32 s50, s47, 12
s_mul_i32 s50, s50, 294912
s_lshl_b32 s51, s48, 6
s_add_u32 s50, s50, s51
s_add_u32 s51, s50, 147456
buffer_load_dwordx4 v[144:147], v248, s[32:35], s50 offen
buffer_load_dwordx4 v[148:151], v248, s[32:35], s51 offen
s_waitcnt vmcnt(4)
L_ffn_sk_21:
s_cmp_ge_u32 s47, 2
s_cbranch_scc1 L_ffn_sk_22
s_add_u32 s50, s47, 16
s_mul_i32 s50, s50, 294912
s_lshl_b32 s51, s48, 6
s_add_u32 s50, s50, s51
s_add_u32 s51, s50, 147456
buffer_load_dwordx4 v[160:163], v248, s[32:35], s50 offen
buffer_load_dwordx4 v[164:167], v248, s[32:35], s51 offen
s_waitcnt vmcnt(4)
L_ffn_sk_22:
s_branch L_postissue
L_ffn:
s_mov_b32 s32, s16
s_and_b32 s33, s17, 0xffff
s_mov_b32 s34, 5308416
s_mov_b32 s35, 0x20000
s_mov_b32 s36, s18
s_and_b32 s37, s19, 0xffff
s_mov_b32 s38, 5308416
s_mov_b32 s39, 0x20000
s_mov_b32 s40, s20
s_and_b32 s41, s21, 0xffff
s_mov_b32 s42, 5308416
s_mov_b32 s43, 0x20000
v_lshrrev_b32 v8, 2, v1
v_mul_u32_u24 v248, 9216, v8
v_and_b32 v8, 3, v1
v_lshl_add_u32 v248, v8, 4, v248
v_lshrrev_b32 v8, 3, v1
v_mul_u32_u24 v249, 1152, v8
v_and_b32 v8, 7, v1
v_lshl_add_u32 v249, v8, 4, v249
v_lshrrev_b32 v8, 4, v1
v_and_b32 v9, 15, v1
v_lshrrev_b32 v10, 2, v9
v_lshl_add_u32 v10, v8, 3, v10
v_and_b32 v11, 3, v9
v_lshlrev_b32 v11, 3, v11
v_lshl_add_u32 v250, v10, 6, v11
v_add_u32 v250, s72, v250
v_lshl_add_u32 v251, v10, 7, v11
v_add_u32 v251, s72, v251
v_lshlrev_b32 v252, 4, v1
v_add_u32 v252, s72, v252
s_waitcnt vmcnt(0)
ds_write_b128 v252, v[96:99] offset:0
ds_write_b128 v252, v[100:103] offset:1024
s_waitcnt lgkmcnt(0)
ds_read_b64_tr_b16 v[96:97], v250 offset:0
ds_read_b64_tr_b16 v[98:99], v250 offset:256
ds_read_b64_tr_b16 v[100:101], v250 offset:32
ds_read_b64_tr_b16 v[102:103], v250 offset:288
s_waitcnt lgkmcnt(0)
L_ffn_xp_23:
ds_write_b128 v252, v[112:115] offset:0
ds_write_b128 v252, v[116:119] offset:1024
s_waitcnt lgkmcnt(0)
ds_read_b64_tr_b16 v[112:113], v250 offset:0
ds_read_b64_tr_b16 v[114:115], v250 offset:256
ds_read_b64_tr_b16 v[116:117], v250 offset:32
ds_read_b64_tr_b16 v[118:119], v250 offset:288
s_waitcnt lgkmcnt(0)
L_ffn_xp_24:
ds_write_b128 v252, v[128:131] offset:0
ds_write_b128 v252, v[132:135] offset:1024
s_waitcnt lgkmcnt(0)
ds_read_b64_tr_b16 v[128:129], v250 offset:0
ds_read_b64_tr_b16 v[130:131], v250 offset:256
ds_read_b64_tr_b16 v[132:133], v250 offset:32
ds_read_b64_tr_b16 v[134:135], v250 offset:288
s_waitcnt lgkmcnt(0)
L_ffn_xp_25:
ds_write_b128 v252, v[144:147] offset:0
ds_write_b128 v252, v[148:151] offset:1024
s_waitcnt lgkmcnt(0)
ds_read_b64_tr_b16 v[144:145], v250 offset:0
ds_read_b64_tr_b16 v[146:147], v250 offset:256
ds_read_b64_tr_b16 v[148:149], v250 offset:32
ds_read_b64_tr_b16 v[150:151], v250 offset:288
s_waitcnt lgkmcnt(0)
L_ffn_xp_26:
s_cmp_ge_u32 s47, 2
s_cbranch_scc1 L_ffn_xp_27
ds_write_b128 v252, v[160:163] offset:0
ds_write_b128 v252, v[164:167] offset:1024
s_waitcnt lgkmcnt(0)
ds_read_b64_tr_b16 v[160:161], v250 offset:0
ds_read_b64_tr_b16 v[162:163], v250 offset:256
ds_read_b64_tr_b16 v[164:165], v250 offset:32
ds_read_b64_tr_b16 v[166:167], v250 offset:288
s_waitcnt lgkmcnt(0)
L_ffn_xp_27:
s_and_b32 s50, s47, 1
s_lshl_b32 s50, s50, 6
v_add_u32 v8, 128, v1
v_min_u32 v8, 143, v8
v_lshrrev_b32 v9, 2, v8
v_lshlrev_b32 v9, 7, v9
v_and_b32 v10, 3, v8
v_lshl_add_u32 v9, v10, 4, v9
v_add_u32 v25, s50, v9
v_lshrrev_b32 v9, 2, v1
v_lshlrev_b32 v9, 7, v9
v_and_b32 v10, 3, v1
v_lshl_add_u32 v9, v10, 4, v9
v_add_u32 v24, s50, v9
v_add_u32 v26, 17920, v24
v_add_u32 v27, 17920, v25
v_add_u32 v28, 22528, v24
v_add_u32 v29, 22528, v25
L_ffn_pp_28:
global_load_dwordx4 v[32:35], v26, s[30:31] sc1
global_load_dwordx4 v[36:39], v26, s[30:31] offset:2048 sc1
global_load_dwordx4 v[40:43], v27, s[30:31] sc1
global_load_dwordx4 v[44:47], v28, s[30:31] sc1
global_load_dwordx4 v[48:51], v28, s[30:31] offset:2048 sc1
global_load_dwordx4 v[52:55], v29, s[30:31] sc1
s_waitcnt vmcnt(0)
s_mov_b64 s[52:53], 0
v_cmp_ne_u32 vcc, v33, v58
s_or_b64 s[52:53], s[52:53], vcc
v_cmp_ne_u32 vcc, v35, v58
s_or_b64 s[52:53], s[52:53], vcc
v_cmp_ne_u32 vcc, v37, v58
s_or_b64 s[52:53], s[52:53], vcc
v_cmp_ne_u32 vcc, v39, v58
s_or_b64 s[52:53], s[52:53], vcc
v_cmp_ne_u32 vcc, v41, v58
s_or_b64 s[52:53], s[52:53], vcc
v_cmp_ne_u32 vcc, v43, v58
s_or_b64 s[52:53], s[52:53], vcc
v_cmp_ne_u32 vcc, v45, v58
s_or_b64 s[52:53], s[52:53], vcc
v_cmp_ne_u32 vcc, v47, v58
s_or_b64 s[52:53], s[52:53], vcc
v_cmp_ne_u32 vcc, v49, v58
s_or_b64 s[52:53], s[52:53], vcc
v_cmp_ne_u32 vcc, v51, v58
s_or_b64 s[52:53], s[52:53], vcc
v_cmp_ne_u32 vcc, v53, v58
s_or_b64 s[52:53], s[52:53], vcc
v_cmp_ne_u32 vcc, v55, v58
s_or_b64 s[52:53], s[52:53], vcc
s_add_u32 s73, s73, 1
s_cmp_gt_u32 s73, 400000
s_movk_i32 s74, 8
s_cbranch_scc1 L_fail
s_cmp_lg_u64 s[52:53], 0
s_cbranch_scc1 L_ffn_pp_28
v_lshlrev_b32 v224, 16, v32
v_and_b32 v225, 0xffff0000, v32
v_lshlrev_b32 v8, 16, v44
v_and_b32 v9, 0xffff0000, v44
v_add_f32 v8, 1.0, v8
v_add_f32 v9, 1.0, v9
v_cvt_pk_bf16_f32 v10, v8, v9
v_lshlrev_b32 v236, 16, v10
v_and_b32 v237, 0xffff0000, v10
v_lshlrev_b32 v226, 16, v34
v_and_b32 v227, 0xffff0000, v34
v_lshlrev_b32 v8, 16, v46
v_and_b32 v9, 0xffff0000, v46
v_add_f32 v8, 1.0, v8
v_add_f32 v9, 1.0, v9
v_cvt_pk_bf16_f32 v10, v8, v9
v_lshlrev_b32 v238, 16, v10
v_and_b32 v239, 0xffff0000, v10
v_lshlrev_b32 v228, 16, v36
v_and_b32 v229, 0xffff0000, v36
v_lshlrev_b32 v8, 16, v48
v_and_b32 v9, 0xffff0000, v48
v_add_f32 v8, 1.0, v8
v_add_f32 v9, 1.0, v9
v_cvt_pk_bf16_f32 v10, v8, v9
v_lshlrev_b32 v240, 16, v10
v_and_b32 v241, 0xffff0000, v10
v_lshlrev_b32 v230, 16, v38
v_and_b32 v231, 0xffff0000, v38
v_lshlrev_b32 v8, 16, v50
v_and_b32 v9, 0xffff0000, v50
v_add_f32 v8, 1.0, v8
v_add_f32 v9, 1.0, v9
v_cvt_pk_bf16_f32 v10, v8, v9
v_lshlrev_b32 v242, 16, v10
v_and_b32 v243, 0xffff0000, v10
v_lshlrev_b32 v232, 16, v40
v_and_b32 v233, 0xffff0000, v40
v_lshlrev_b32 v8, 16, v52
v_and_b32 v9, 0xffff0000, v52
v_add_f32 v8, 1.0, v8
v_add_f32 v9, 1.0, v9
v_cvt_pk_bf16_f32 v10, v8, v9
v_lshlrev_b32 v244, 16, v10
v_and_b32 v245, 0xffff0000, v10
v_lshlrev_b32 v234, 16, v42
v_and_b32 v235, 0xffff0000, v42
v_lshlrev_b32 v8, 16, v54
v_and_b32 v9, 0xffff0000, v54
v_add_f32 v8, 1.0, v8
v_add_f32 v9, 1.0, v9
v_cvt_pk_bf16_f32 v10, v8, v9
v_lshlrev_b32 v246, 16, v10
v_and_b32 v247, 0xffff0000, v10
s_and_b32 s50, s47, 1
s_mul_i32 s51, s50, 2304
s_add_u32 s51, s51, 786432
s_and_b32 s52, s2, 7
s_mul_i32 s52, s52, 4608
s_add_u32 s51, s51, s52
v_lshlrev_b32 v8, 4, v1
v_add_u32 v20, s51, v8
v_add_u32 v8, 128, v1
v_min_u32 v9, 143, v8
v_lshlrev_b32 v10, 4, v9
v_add_u32 v21, s51, v10
s_mul_i32 s51, s50, 1152
s_add_u32 s51, s51, 151552
v_lshlrev_b32 v10, 3, v1
v_add_u32 v22, s51, v10
v_lshlrev_b32 v10, 3, v9
v_add_u32 v23, s51, v10
v_cmp_gt_u32 vcc, 144, v8
s_nop 1
v_cndmask_b32 v19, 0, 1.0, vcc
v_add_u32 v18, 151552, v5
s_mul_i32 s50, s48, 4608
s_add_u32 s50, s50, 851968
s_lshl_b32 s51, s47, 8
s_add_u32 s62, s50, s51
v_bfe_u32 v8, v1, 4, 1
v_mul_u32_u24 v17, 2304, v8
v_lshrrev_b32 v8, 5, v1
v_lshlrev_b32 v8, 4, v8
v_and_b32 v9, 15, v1
v_add_u32 v8, v8, v9
v_lshl_add_u32 v17, v8, 2, v17
v_add_u32 v17, s62, v17
s_mov_b32 s56, 0
s_mov_b32 s57, -1
s_mov_b32 s32, s16
s_and_b32 s33, s17, 0xffff
s_mov_b32 s34, 5308416
s_mov_b32 s35, 0x20000
s_mov_b32 s36, s18
s_and_b32 s37, s19, 0xffff
s_mov_b32 s38, 5308416
s_mov_b32 s39, 0x20000
s_mov_b32 s40, s20
s_and_b32 s41, s21, 0xffff
s_mov_b32 s42, 5308416
s_mov_b32 s43, 0x20000
v_lshrrev_b32 v8, 2, v1
v_mul_u32_u24 v248, 9216, v8
v_and_b32 v8, 3, v1
v_lshl_add_u32 v248, v8, 4, v248
v_lshrrev_b32 v8, 3, v1
v_mul_u32_u24 v249, 1152, v8
v_and_b32 v8, 7, v1
v_lshl_add_u32 v249, v8, 4, v249
v_lshrrev_b32 v8, 4, v1
v_and_b32 v9, 15, v1
v_lshrrev_b32 v10, 2, v9
v_lshl_add_u32 v10, v8, 3, v10
v_and_b32 v11, 3, v9
v_lshlrev_b32 v11, 3, v11
v_lshl_add_u32 v250, v10, 6, v11
v_add_u32 v250, s72, v250
v_lshl_add_u32 v251, v10, 7, v11
v_add_u32 v251, s72, v251
v_lshlrev_b32 v252, 4, v1
v_add_u32 v252, s72, v252
v_and_b32 v8, 31, v1
v_lshlrev_b32 v8, 2, v8
s_lshl_b32 s50, s47, 9
s_add_u32 s50, s50, 153856
v_add_u32 v28, s50, v8
v_bfe_u32 v8, v1, 4, 1
v_lshlrev_b32 v8, 7, v8
v_lshrrev_b32 v9, 5, v1
v_lshlrev_b32 v9, 4, v9
v_and_b32 v10, 15, v1
v_add_u32 v9, v9, v10
v_lshl_add_u32 v8, v9, 2, v8
v_add_u32 v253, 153856, v8
s_lshl_b32 s50, s47, 7
s_add_u32 s50, s50, 162240
v_lshlrev_b32 v8, 1, v1
v_add_u32 v254, s50, v8
v_bfe_u32 v8, v1, 2, 1
v_lshlrev_b32 v8, 6, v8
v_lshrrev_b32 v9, 4, v1
v_lshl_add_u32 v8, v9, 4, v8
v_add_u32 v255, s50, v8
v_mov_b32 v14, 0
L_wi_29:
s_add_u32 s73, s73, 1
s_cmp_gt_u32 s73, 400000
s_movk_i32 s74, 3
s_cbranch_scc1 L_fail
global_load_dword v15, v14, s[28:29] sc1
s_waitcnt vmcnt(0)
v_readfirstlane_b32 s50, v15
s_cmp_ge_u32 s50, 256
s_cbranch_scc0 L_wi_29
s_barrier
v_mov_b32 v63, 161944
L_lw_30:
s_add_u32 s73, s73, 1
s_cmp_gt_u32 s73, 400000
s_movk_i32 s74, 18
s_cbranch_scc1 L_fail
ds_read_b32 v62, v63
s_waitcnt lgkmcnt(0)
v_readfirstlane_b32 s71, v62
s_cmp_ge_u32 s71, 1
s_cbranch_scc0 L_lw_30
s_add_u32 s50, s47, 0
s_mul_i32 s50, s50, 294912
s_lshl_b32 s51, s48, 6
s_add_u32 s50, s50, s51
s_add_u32 s51, s50, 147456
buffer_load_dwordx4 v[104:107], v248, s[36:39], s50 offen
buffer_load_dwordx4 v[108:111], v248, s[36:39], s51 offen
L_ffn_sk_31:
s_add_u32 s50, s47, 4
s_mul_i32 s50, s50, 294912
s_lshl_b32 s51, s48, 6
s_add_u32 s50, s50, s51
s_add_u32 s51, s50, 147456
buffer_load_dwordx4 v[120:123], v248, s[36:39], s50 offen
buffer_load_dwordx4 v[124:127], v248, s[36:39], s51 offen
L_ffn_sk_32:
s_add_u32 s50, s47, 8
s_mul_i32 s50, s50, 294912
s_lshl_b32 s51, s48, 6
s_add_u32 s50, s50, s51
s_add_u32 s51, s50, 147456
buffer_load_dwordx4 v[136:139], v248, s[36:39], s50 offen
buffer_load_dwordx4 v[140:143], v248, s[36:39], s51 offen
L_ffn_sk_33:
s_add_u32 s50, s47, 12
s_mul_i32 s50, s50, 294912
s_lshl_b32 s51, s48, 6
s_add_u32 s50, s50, s51
s_add_u32 s51, s50, 147456
buffer_load_dwordx4 v[152:155], v248, s[36:39], s50 offen
buffer_load_dwordx4 v[156:159], v248, s[36:39], s51 offen
L_ffn_sk_34:
s_cmp_ge_u32 s47, 2
s_cbranch_scc1 L_ffn_sk_35
s_add_u32 s50, s47, 16
s_mul_i32 s50, s50, 294912
s_lshl_b32 s51, s48, 6
s_add_u32 s50, s50, s51
s_add_u32 s51, s50, 147456
buffer_load_dwordx4 v[168:171], v248, s[36:39], s50 offen
buffer_load_dwordx4 v[172:175], v248, s[36:39], s51 offen
L_ffn_sk_35:
s_mul_i32 s50, s48, 36864
s_lshl_b32 s55, s47, 7
s_add_u32 s50, s50, s55
s_add_u32 s51, s50, 0
buffer_load_dwordx4 v[176:179], v249, s[40:43], s51 offen nt
s_add_u32 s51, s51, 9216
buffer_load_dwordx4 v[180:183], v249, s[40:43], s51 offen nt
s_add_u32 s51, s51, 9216
buffer_load_dwordx4 v[184:187], v249, s[40:43], s51 offen nt
s_add_u32 s51, s51, 9216
buffer_load_dwordx4 v[188:191], v249, s[40:43], s51 offen nt
L_ffn_dk_36:
s_mul_i32 s50, s48, 36864
s_lshl_b32 s55, s47, 7
s_add_u32 s50, s50, s55
s_add_u32 s51, s50, 512
buffer_load_dwordx4 v[192:195], v249, s[40:43], s51 offen nt
s_add_u32 s51, s51, 9216
buffer_load_dwordx4 v[196:199], v249, s[40:43], s51 offen nt
s_add_u32 s51, s51, 9216
buffer_load_dwordx4 v[200:203], v249, s[40:43], s51 offen nt
s_add_u32 s51, s51, 9216
buffer_load_dwordx4 v[204:207], v249, s[40:43], s51 offen nt
L_ffn_dk_37:
s_cmp_lg_u32 s47, 0
s_cbranch_scc1 L_ffn_dk_38
s_mul_i32 s50, s48, 36864
s_lshl_b32 s55, s47, 7
s_add_u32 s50, s50, s55
s_add_u32 s51, s50, 1024
buffer_load_dwordx4 v[208:211], v249, s[40:43], s51 offen nt
s_add_u32 s51, s51, 9216
buffer_load_dwordx4 v[212:215], v249, s[40:43], s51 offen nt
s_add_u32 s51, s51, 9216
buffer_load_dwordx4 v[216:219], v249, s[40:43], s51 offen nt
s_add_u32 s51, s51, 9216
buffer_load_dwordx4 v[220:223], v249, s[40:43], s51 offen nt
L_ffn_dk_38:
s_waitcnt vmcnt(0)
s_cmp_lt_u32 s47, 2
s_cbranch_scc0 L_ffn_nl
global_load_dwordx4 v[32:35], v20, s[30:31] sc1
global_load_dwordx4 v[36:39], v20, s[30:31] offset:1024 sc1
global_load_dwordx4 v[40:43], v21, s[30:31] sc1
L_ffn_nl:
ds_write_b128 v252, v[104:107] offset:2048
ds_write_b128 v252, v[108:111] offset:3072
s_waitcnt lgkmcnt(0)
ds_read_b64_tr_b16 v[104:105], v250 offset:2048
ds_read_b64_tr_b16 v[106:107], v250 offset:2304
ds_read_b64_tr_b16 v[108:109], v250 offset:2080
ds_read_b64_tr_b16 v[110:111], v250 offset:2336
s_waitcnt lgkmcnt(0)
L_ffn_xp_39:
ds_write_b128 v252, v[120:123] offset:2048
ds_write_b128 v252, v[124:127] offset:3072
s_waitcnt lgkmcnt(0)
ds_read_b64_tr_b16 v[120:121], v250 offset:2048
ds_read_b64_tr_b16 v[122:123], v250 offset:2304
ds_read_b64_tr_b16 v[124:125], v250 offset:2080
ds_read_b64_tr_b16 v[126:127], v250 offset:2336
s_waitcnt lgkmcnt(0)
L_ffn_xp_40:
ds_write_b128 v252, v[136:139] offset:2048
ds_write_b128 v252, v[140:143] offset:3072
s_waitcnt lgkmcnt(0)
ds_read_b64_tr_b16 v[136:137], v250 offset:2048
ds_read_b64_tr_b16 v[138:139], v250 offset:2304
ds_read_b64_tr_b16 v[140:141], v250 offset:2080
ds_read_b64_tr_b16 v[142:143], v250 offset:2336
s_waitcnt lgkmcnt(0)
L_ffn_xp_41:
ds_write_b128 v252, v[152:155] offset:2048
ds_write_b128 v252, v[156:159] offset:3072
s_waitcnt lgkmcnt(0)
ds_read_b64_tr_b16 v[152:153], v250 offset:2048
ds_read_b64_tr_b16 v[154:155], v250 offset:2304
ds_read_b64_tr_b16 v[156:157], v250 offset:2080
ds_read_b64_tr_b16 v[158:159], v250 offset:2336
s_waitcnt lgkmcnt(0)
L_ffn_xp_42:
s_cmp_ge_u32 s47, 2
s_cbranch_scc1 L_ffn_xp_43
ds_write_b128 v252, v[168:171] offset:2048
ds_write_b128 v252, v[172:175] offset:3072
s_waitcnt lgkmcnt(0)
ds_read_b64_tr_b16 v[168:169], v250 offset:2048
ds_read_b64_tr_b16 v[170:171], v250 offset:2304
ds_read_b64_tr_b16 v[172:173], v250 offset:2080
ds_read_b64_tr_b16 v[174:175], v250 offset:2336
s_waitcnt lgkmcnt(0)
L_ffn_xp_43:
ds_write_b128 v252, v[176:179] offset:0
ds_write_b128 v252, v[180:183] offset:1024
ds_write_b128 v252, v[184:187] offset:2048
ds_write_b128 v252, v[188:191] offset:3072
s_waitcnt lgkmcnt(0)
ds_read_b64_tr_b16 v[176:177], v251 offset:0
ds_read_b64_tr_b16 v[178:179], v251 offset:512
ds_read_b64_tr_b16 v[180:181], v251 offset:32
ds_read_b64_tr_b16 v[182:183], v251 offset:544
ds_read_b64_tr_b16 v[184:185], v251 offset:64
ds_read_b64_tr_b16 v[186:187], v251 offset:576
ds_read_b64_tr_b16 v[188:189], v251 offset:96
ds_read_b64_tr_b16 v[190:191], v251 offset:608
s_waitcnt lgkmcnt(0)
L_ffn_xd_44:
ds_write_b128 v252, v[192:195] offset:0
ds_write_b128 v252, v[196:199] offset:1024
ds_write_b128 v252, v[200:203] offset:2048
ds_write_b128 v252, v[204:207] offset:3072
s_waitcnt lgkmcnt(0)
ds_read_b64_tr_b16 v[192:193], v251 offset:0
ds_read_b64_tr_b16 v[194:195], v251 offset:512
ds_read_b64_tr_b16 v[196:197], v251 offset:32
ds_read_b64_tr_b16 v[198:199], v251 offset:544
ds_read_b64_tr_b16 v[200:201], v251 offset:64
ds_read_b64_tr_b16 v[202:203], v251 offset:576
ds_read_b64_tr_b16 v[204:205], v251 offset:96
ds_read_b64_tr_b16 v[206:207], v251 offset:608
s_waitcnt lgkmcnt(0)
L_ffn_xd_45:
s_cmp_lg_u32 s47, 0
s_cbranch_scc1 L_ffn_xd_46
ds_write_b128 v252, v[208:211] offset:0
ds_write_b128 v252, v[212:215] offset:1024
ds_write_b128 v252, v[216:219] offset:2048
ds_write_b128 v252, v[220:223] offset:3072
s_waitcnt lgkmcnt(0)
ds_read_b64_tr_b16 v[208:209], v251 offset:0
ds_read_b64_tr_b16 v[210:211], v251 offset:512
ds_read_b64_tr_b16 v[212:213], v251 offset:32
ds_read_b64_tr_b16 v[214:215], v251 offset:544
ds_read_b64_tr_b16 v[216:217], v251 offset:64
ds_read_b64_tr_b16 v[218:219], v251 offset:576
ds_read_b64_tr_b16 v[220:221], v251 offset:96
ds_read_b64_tr_b16 v[222:223], v251 offset:608
s_waitcnt lgkmcnt(0)
L_ffn_xd_46:
s_mov_b32 s54, 0xbfb8aa3b
s_cmp_lt_u32 s47, 2
s_cbranch_scc0 L_ffn_nx
s_branch L_hopC1_48
L_hopC_47:
global_load_dwordx4 v[32:35], v20, s[30:31] sc1
global_load_dwordx4 v[36:39], v20, s[30:31] offset:1024 sc1
global_load_dwordx4 v[40:43], v21, s[30:31] sc1
L_hopC1_48:
s_waitcnt vmcnt(0)
s_mov_b64 s[52:53], 0
v_cmp_eq_u32 vcc, -1, v32
s_or_b64 s[52:53], s[52:53], vcc
v_cmp_eq_u32 vcc, -1, v33
s_or_b64 s[52:53], s[52:53], vcc
v_cmp_eq_u32 vcc, -1, v34
s_or_b64 s[52:53], s[52:53], vcc
v_cmp_eq_u32 vcc, -1, v35
s_or_b64 s[52:53], s[52:53], vcc
v_cmp_eq_u32 vcc, -1, v36
s_or_b64 s[52:53], s[52:53], vcc
v_cmp_eq_u32 vcc, -1, v37
s_or_b64 s[52:53], s[52:53], vcc
v_cmp_eq_u32 vcc, -1, v38
s_or_b64 s[52:53], s[52:53], vcc
v_cmp_eq_u32 vcc, -1, v39
s_or_b64 s[52:53], s[52:53], vcc
v_cmp_eq_u32 vcc, -1, v40
s_or_b64 s[52:53], s[52:53], vcc
v_cmp_eq_u32 vcc, -1, v41
s_or_b64 s[52:53], s[52:53], vcc
v_cmp_eq_u32 vcc, -1, v42
s_or_b64 s[52:53], s[52:53], vcc
v_cmp_eq_u32 vcc, -1, v43
s_or_b64 s[52:53], s[52:53], vcc
s_add_u32 s73, s73, 1
s_cmp_gt_u32 s73, 400000
s_movk_i32 s74, 9
s_cbranch_scc1 L_fail
s_cmp_lg_u64 s[52:53], 0
s_cbranch_scc1 L_hopC_47
v_readfirstlane_b32 s55, v32
s_nop 1
v_mov_b32 v12, s55
v_sub_f32 v12, 0, v12
v_mov_b32 v13, v12
v_pk_add_f32 v[44:45], v[32:33], v[12:13]
v_pk_add_f32 v[46:47], v[34:35], v[12:13]
v_pk_add_f32 v[48:49], v[36:37], v[12:13]
v_pk_add_f32 v[50:51], v[38:39], v[12:13]
v_pk_add_f32 v[52:53], v[40:41], v[12:13]
v_pk_add_f32 v[54:55], v[42:43], v[12:13]
v_mul_f32 v52, v52, v19
v_mul_f32 v53, v53, v19
v_mul_f32 v54, v54, v19
v_mul_f32 v55, v55, v19
v_pk_mul_f32 v[10:11], v[44:45], v[44:45]
v_pk_add_f32 v[8:9], v[44:45], v[46:47]
v_pk_fma_f32 v[10:11], v[46:47], v[46:47], v[10:11]
v_pk_fma_f32 v[10:11], v[48:49], v[48:49], v[10:11]
v_pk_add_f32 v[8:9], v[8:9], v[48:49]
v_pk_fma_f32 v[10:11], v[50:51], v[50:51], v[10:11]
v_pk_add_f32 v[8:9], v[8:9], v[50:51]
v_pk_fma_f32 v[10:11], v[52:53], v[52:53], v[10:11]
v_pk_add_f32 v[8:9], v[8:9], v[52:53]
v_pk_fma_f32 v[10:11], v[54:55], v[54:55], v[10:11]
v_pk_add_f32 v[8:9], v[8:9], v[54:55]
v_add_f32 v8, v8, v9
v_add_f32 v11, v10, v11
s_nop 0
v_add_f32_dpp v8, v8, v8 quad_perm:[1,0,3,2] row_mask:0xf bank_mask:0xf
v_add_f32_dpp v11, v11, v11 quad_perm:[1,0,3,2] row_mask:0xf bank_mask:0xf
s_nop 0
v_add_f32_dpp v8, v8, v8 quad_perm:[2,3,0,1] row_mask:0xf bank_mask:0xf
v_add_f32_dpp v11, v11, v11 quad_perm:[2,3,0,1] row_mask:0xf bank_mask:0xf
s_nop 0
v_add_f32_dpp v8, v8, v8 row_half_mirror row_mask:0xf bank_mask:0xf
v_add_f32_dpp v11, v11, v11 row_half_mirror row_mask:0xf bank_mask:0xf
s_nop 0
v_add_f32_dpp v8, v8, v8 row_ror:8 row_mask:0xf bank_mask:0xf
v_add_f32_dpp v11, v11, v11 row_ror:8 row_mask:0xf bank_mask:0xf
v_mov_b32 v9, v8
v_mov_b32 v10, v11
s_nop 0
v_permlane16_swap_b32 v9, v8
v_permlane16_swap_b32 v10, v11
v_add_f32 v8, v8, v9
v_add_f32 v11, v11, v10
v_mov_b32 v9, v8
v_mov_b32 v10, v11
s_nop 0
v_permlane32_swap_b32 v9, v8
v_permlane32_swap_b32 v10, v11
v_add_f32 v8, v8, v9
v_add_f32 v11, v11, v10
v_mul_f32 v8, 0x3ae38e39, v8
v_mul_f32 v11, 0x3ae38e39, v11
v_fma_f32 v11, -v8, v8, v11
v_max_f32 v11, 0, v11
v_add_f32 v8, s55, v8
v_cvt_pk_bf16_f32 v9, v8, v8
v_lshlrev_b32 v8, 16, v9
v_cvt_pk_bf16_f32 v9, v11, v11
v_lshlrev_b32 v11, 16, v9
v_add_f32 v11, 0x3727c5ac, v11
v_cvt_pk_bf16_f32 v9, v11, v11
v_lshlrev_b32 v11, 16, v9
v_sqrt_f32 v11, v11
s_nop 0
v_cvt_pk_bf16_f32 v9, v11, v11
v_lshlrev_b32 v11, 16, v9
v_rcp_f32 v11, v11
v_sub_f32 v12, 0, v8
v_mov_b32 v13, v12
v_mov_b32 v14, v11
v_mov_b32 v15, v11
v_pk_add_f32 v[32:33], v[32:33], v[12:13]
v_pk_add_f32 v[34:35], v[34:35], v[12:13]
v_pk_add_f32 v[36:37], v[36:37], v[12:13]
v_pk_add_f32 v[38:39], v[38:39], v[12:13]
v_pk_add_f32 v[40:41], v[40:41], v[12:13]
v_pk_add_f32 v[42:43], v[42:43], v[12:13]
v_cvt_pk_bf16_f32 v44, v32, v33
v_cvt_pk_bf16_f32 v45, v34, v35
v_cvt_pk_bf16_f32 v46, v36, v37
v_cvt_pk_bf16_f32 v47, v38, v39
v_cvt_pk_bf16_f32 v48, v40, v41
v_cvt_pk_bf16_f32 v49, v42, v43
v_lshlrev_b32 v32, 16, v44
v_and_b32 v33, 0xffff0000, v44
v_lshlrev_b32 v34, 16, v45
v_and_b32 v35, 0xffff0000, v45
v_lshlrev_b32 v36, 16, v46
v_and_b32 v37, 0xffff0000, v46
v_lshlrev_b32 v38, 16, v47
v_and_b32 v39, 0xffff0000, v47
v_lshlrev_b32 v40, 16, v48
v_and_b32 v41, 0xffff0000, v48
v_lshlrev_b32 v42, 16, v49
v_and_b32 v43, 0xffff0000, v49
v_pk_mul_f32 v[32:33], v[32:33], v[14:15]
v_pk_mul_f32 v[34:35], v[34:35], v[14:15]
v_pk_mul_f32 v[36:37], v[36:37], v[14:15]
v_pk_mul_f32 v[38:39], v[38:39], v[14:15]
v_pk_mul_f32 v[40:41], v[40:41], v[14:15]
v_pk_mul_f32 v[42:43], v[42:43], v[14:15]
v_cvt_pk_bf16_f32 v44, v32, v33
v_cvt_pk_bf16_f32 v45, v34, v35
v_cvt_pk_bf16_f32 v46, v36, v37
v_cvt_pk_bf16_f32 v47, v38, v39
v_cvt_pk_bf16_f32 v48, v40, v41
v_cvt_pk_bf16_f32 v49, v42, v43
v_lshlrev_b32 v32, 16, v44
v_and_b32 v33, 0xffff0000, v44
v_lshlrev_b32 v34, 16, v45
v_and_b32 v35, 0xffff0000, v45
v_lshlrev_b32 v36, 16, v46
v_and_b32 v37, 0xffff0000, v46
v_lshlrev_b32 v38, 16, v47
v_and_b32 v39, 0xffff0000, v47
v_lshlrev_b32 v40, 16, v48
v_and_b32 v41, 0xffff0000, v48
v_lshlrev_b32 v42, 16, v49
v_and_b32 v43, 0xffff0000, v49
v_pk_mul_f32 v[32:33], v[32:33], v[236:237]
v_pk_mul_f32 v[34:35], v[34:35], v[238:239]
v_pk_mul_f32 v[36:37], v[36:37], v[240:241]
v_pk_mul_f32 v[38:39], v[38:39], v[242:243]
v_pk_mul_f32 v[40:41], v[40:41], v[244:245]
v_pk_mul_f32 v[42:43], v[42:43], v[246:247]
v_cvt_pk_bf16_f32 v44, v32, v33
v_cvt_pk_bf16_f32 v45, v34, v35
v_cvt_pk_bf16_f32 v46, v36, v37
v_cvt_pk_bf16_f32 v47, v38, v39
v_cvt_pk_bf16_f32 v48, v40, v41
v_cvt_pk_bf16_f32 v49, v42, v43
v_lshlrev_b32 v32, 16, v44
v_and_b32 v33, 0xffff0000, v44
v_lshlrev_b32 v34, 16, v45
v_and_b32 v35, 0xffff0000, v45
v_lshlrev_b32 v36, 16, v46
v_and_b32 v37, 0xffff0000, v46
v_lshlrev_b32 v38, 16, v47
v_and_b32 v39, 0xffff0000, v47
v_lshlrev_b32 v40, 16, v48
v_and_b32 v41, 0xffff0000, v48
v_lshlrev_b32 v42, 16, v49
v_and_b32 v43, 0xffff0000, v49
v_pk_add_f32 v[32:33], v[32:33], v[224:225]
v_pk_add_f32 v[34:35], v[34:35], v[226:227]
v_pk_add_f32 v[36:37], v[36:37], v[228:229]
v_pk_add_f32 v[38:39], v[38:39], v[230:231]
v_pk_add_f32 v[40:41], v[40:41], v[232:233]
v_pk_add_f32 v[42:43], v[42:43], v[234:235]
v_cvt_pk_bf16_f32 v44, v32, v33
v_cvt_pk_bf16_f32 v45, v34, v35
v_cvt_pk_bf16_f32 v46, v36, v37
v_cvt_pk_bf16_f32 v47, v38, v39
v_cvt_pk_bf16_f32 v48, v40, v41
v_cvt_pk_bf16_f32 v49, v42, v43
ds_write_b64 v22, v[44:45]
ds_write_b64 v22, v[46:47] offset:512
ds_write_b64 v23, v[48:49]
s_waitcnt lgkmcnt(0)
L_ffn_nx:
s_barrier
ds_read_b128 v[32:35], v18 offset:0
ds_read_b128 v[36:39], v18 offset:256
ds_read_b128 v[40:43], v18 offset:512
ds_read_b128 v[44:47], v18 offset:768
ds_read_b128 v[48:51], v18 offset:1024
s_waitcnt lgkmcnt(0)
v_mfma_f32_16x16x32_bf16 v[64:67], v[32:35], v[96:99], 0
v_mfma_f32_16x16x32_bf16 v[68:71], v[32:35], v[100:103], 0
v_mfma_f32_16x16x32_bf16 v[72:75], v[32:35], v[104:107], 0
v_mfma_f32_16x16x32_bf16 v[76:79], v[32:35], v[108:111], 0
v_mfma_f32_16x16x32_bf16 v[64:67], v[36:39], v[112:115], v[64:67]
v_mfma_f32_16x16x32_bf16 v[68:71], v[36:39], v[116:119], v[68:71]
v_mfma_f32_16x16x32_bf16 v[72:75], v[36:39], v[120:123], v[72:75]
v_mfma_f32_16x16x32_bf16 v[76:79], v[36:39], v[124:127], v[76:79]
v_mfma_f32_16x16x32_bf16 v[64:67], v[40:43], v[128:131], v[64:67]
v_mfma_f32_16x16x32_bf16 v[68:71], v[40:43], v[132:135], v[68:71]
v_mfma_f32_16x16x32_bf16 v[72:75], v[40:43], v[136:139], v[72:75]
v_mfma_f32_16x16x32_bf16 v[76:79], v[40:43], v[140:143], v[76:79]
v_mfma_f32_16x16x32_bf16 v[64:67], v[44:47], v[144:147], v[64:67]
v_mfma_f32_16x16x32_bf16 v[68:71], v[44:47], v[148:151], v[68:71]
v_mfma_f32_16x16x32_bf16 v[72:75], v[44:47], v[152:155], v[72:75]
v_mfma_f32_16x16x32_bf16 v[76:79], v[44:47], v[156:159], v[76:79]
s_cmp_ge_u32 s47, 2
s_cbranch_scc1 L_ffn_m5_49
v_mfma_f32_16x16x32_bf16 v[64:67], v[48:51], v[160:163], v[64:67]
v_mfma_f32_16x16x32_bf16 v[68:71], v[48:51], v[164:167], v[68:71]
v_mfma_f32_16x16x32_bf16 v[72:75], v[48:51], v[168:171], v[72:75]
v_mfma_f32_16x16x32_bf16 v[76:79], v[48:51], v[172:175], v[76:79]
L_ffn_m5_49:
s_nop 7
ds_write_b32 v28, v64
ds_write_b32 v28, v68 offset:128
ds_write_b32 v28, v72 offset:256
ds_write_b32 v28, v76 offset:384
s_waitcnt lgkmcnt(0)
s_barrier
ds_read_b32 v32, v253 offset:0
ds_read_b32 v36, v253 offset:256
ds_read_b32 v33, v253 offset:512
ds_read_b32 v37, v253 offset:768
ds_read_b32 v34, v253 offset:1024
ds_read_b32 v38, v253 offset:1280
ds_read_b32 v35, v253 offset:1536
ds_read_b32 v39, v253 offset:1792
s_waitcnt lgkmcnt(0)
v_add_f32 v32, v32, v33
v_add_f32 v34, v34, v35
v_add_f32 v36, v36, v37
v_add_f32 v38, v38, v39
v_add_f32 v32, v32, v34
v_add_f32 v36, v36, v38
v_cvt_pk_bf16_f32 v9, v32, v36
v_lshlrev_b32 v32, 16, v9
v_and_b32 v36, 0xffff0000, v9
v_mul_f32 v10, s54, v32
v_exp_f32 v10, v10
s_nop 0
v_add_f32 v10, 1.0, v10
v_rcp_f32 v10, v10
s_nop 0
v_mul_f32 v32, v32, v10
v_cvt_pk_bf16_f32 v9, v32, v32
v_lshlrev_b32 v32, 16, v9
v_mul_f32 v32, v32, v36
v_cvt_pk_bf16_f32 v32, v32, v32
ds_write_b16 v254, v32
s_waitcnt lgkmcnt(0)
ds_read_b128 v[24:27], v255
s_waitcnt lgkmcnt(0)
v_mfma_f32_16x16x32_bf16 v[32:35], v[24:27], v[176:179], 0
v_mfma_f32_16x16x32_bf16 v[36:39], v[24:27], v[180:183], 0
v_mfma_f32_16x16x32_bf16 v[40:43], v[24:27], v[184:187], 0
v_mfma_f32_16x16x32_bf16 v[44:47], v[24:27], v[188:191], 0
s_nop 7
v_cndmask_b32 v48, v32, v36, s[56:57]
v_min_u32 v48, -2, v48
global_store_dword v17, v48, s[30:31] offset:0 sc0 sc1
v_cndmask_b32 v49, v40, v44, s[56:57]
v_min_u32 v49, -2, v49
global_store_dword v17, v49, s[30:31] offset:128 sc0 sc1
L_ffn_mk_50:
v_mfma_f32_16x16x32_bf16 v[32:35], v[24:27], v[192:195], 0
v_mfma_f32_16x16x32_bf16 v[36:39], v[24:27], v[196:199], 0
v_mfma_f32_16x16x32_bf16 v[40:43], v[24:27], v[200:203], 0
v_mfma_f32_16x16x32_bf16 v[44:47], v[24:27], v[204:207], 0
s_nop 7
v_cndmask_b32 v48, v32, v36, s[56:57]
v_min_u32 v48, -2, v48
global_store_dword v17, v48, s[30:31] offset:1024 sc0 sc1
v_cndmask_b32 v49, v40, v44, s[56:57]
v_min_u32 v49, -2, v49
global_store_dword v17, v49, s[30:31] offset:1152 sc0 sc1
L_ffn_mk_51:
s_cmp_lg_u32 s47, 0
s_cbranch_scc1 L_ffn_mk_52
v_mfma_f32_16x16x32_bf16 v[32:35], v[24:27], v[208:211], 0
v_mfma_f32_16x16x32_bf16 v[36:39], v[24:27], v[212:215], 0
v_mfma_f32_16x16x32_bf16 v[40:43], v[24:27], v[216:219], 0
v_mfma_f32_16x16x32_bf16 v[44:47], v[24:27], v[220:223], 0
s_nop 7
v_cndmask_b32 v48, v32, v36, s[56:57]
v_min_u32 v48, -2, v48
global_store_dword v17, v48, s[30:31] offset:2048 sc0 sc1
v_cndmask_b32 v49, v40, v44, s[56:57]
v_min_u32 v49, -2, v49
global_store_dword v17, v49, s[30:31] offset:2176 sc0 sc1
L_ffn_mk_52:
s_branch L_hdone
L_wo:
s_waitcnt vmcnt(0)
ds_write_b128 v59, v[96:99] offset:0
ds_write_b128 v59, v[100:103] offset:1024
ds_write_b128 v59, v[104:107] offset:2048
ds_write_b128 v59, v[108:111] offset:3072
s_waitcnt lgkmcnt(0)
ds_read_b64_tr_b16 v[96:97], v7 offset:0
ds_read_b64_tr_b16 v[98:99], v7 offset:512
ds_read_b64_tr_b16 v[100:101], v7 offset:32
ds_read_b64_tr_b16 v[102:103], v7 offset:544
ds_read_b64_tr_b16 v[104:105], v7 offset:64
ds_read_b64_tr_b16 v[106:107], v7 offset:576
ds_read_b64_tr_b16 v[108:109], v7 offset:96
ds_read_b64_tr_b16 v[110:111], v7 offset:608
s_waitcnt lgkmcnt(0)
ds_write_b128 v59, v[112:115] offset:0
ds_write_b128 v59, v[116:119] offset:1024
ds_write_b128 v59, v[120:123] offset:2048
ds_write_b128 v59, v[124:127] offset:3072
s_waitcnt lgkmcnt(0)
ds_read_b64_tr_b16 v[112:113], v7 offset:0
ds_read_b64_tr_b16 v[114:115], v7 offset:512
ds_read_b64_tr_b16 v[116:117], v7 offset:32
ds_read_b64_tr_b16 v[118:119], v7 offset:544
ds_read_b64_tr_b16 v[120:121], v7 offset:64
ds_read_b64_tr_b16 v[122:123], v7 offset:576
ds_read_b64_tr_b16 v[124:125], v7 offset:96
ds_read_b64_tr_b16 v[126:127], v7 offset:608
s_waitcnt lgkmcnt(0)
L_wo_xp_53:
ds_write_b128 v59, v[128:131] offset:0
ds_write_b128 v59, v[132:135] offset:1024
ds_write_b128 v59, v[136:139] offset:2048
ds_write_b128 v59, v[140:143] offset:3072
s_waitcnt lgkmcnt(0)
ds_read_b64_tr_b16 v[128:129], v7 offset:0
ds_read_b64_tr_b16 v[130:131], v7 offset:512
ds_read_b64_tr_b16 v[132:133], v7 offset:32
ds_read_b64_tr_b16 v[134:135], v7 offset:544
ds_read_b64_tr_b16 v[136:137], v7 offset:64
ds_read_b64_tr_b16 v[138:139], v7 offset:576
ds_read_b64_tr_b16 v[140:141], v7 offset:96
ds_read_b64_tr_b16 v[142:143], v7 offset:608
s_waitcnt lgkmcnt(0)
ds_write_b128 v59, v[144:147] offset:0
ds_write_b128 v59, v[148:151] offset:1024
ds_write_b128 v59, v[152:155] offset:2048
ds_write_b128 v59, v[156:159] offset:3072
s_waitcnt lgkmcnt(0)
ds_read_b64_tr_b16 v[144:145], v7 offset:0
ds_read_b64_tr_b16 v[146:147], v7 offset:512
ds_read_b64_tr_b16 v[148:149], v7 offset:32
ds_read_b64_tr_b16 v[150:151], v7 offset:544
ds_read_b64_tr_b16 v[152:153], v7 offset:64
ds_read_b64_tr_b16 v[154:155], v7 offset:576
ds_read_b64_tr_b16 v[156:157], v7 offset:96
ds_read_b64_tr_b16 v[158:159], v7 offset:608
s_waitcnt lgkmcnt(0)
L_wo_xp_54:
s_cmp_lg_u32 s47, 0
s_cbranch_scc1 L_wo_xp_55
ds_write_b128 v59, v[160:163] offset:0
ds_write_b128 v59, v[164:167] offset:1024
ds_write_b128 v59, v[168:171] offset:2048
ds_write_b128 v59, v[172:175] offset:3072
s_waitcnt lgkmcnt(0)
ds_read_b64_tr_b16 v[160:161], v7 offset:0
ds_read_b64_tr_b16 v[162:163], v7 offset:512
ds_read_b64_tr_b16 v[164:165], v7 offset:32
ds_read_b64_tr_b16 v[166:167], v7 offset:544
ds_read_b64_tr_b16 v[168:169], v7 offset:64
ds_read_b64_tr_b16 v[170:171], v7 offset:576
ds_read_b64_tr_b16 v[172:173], v7 offset:96
ds_read_b64_tr_b16 v[174:175], v7 offset:608
s_waitcnt lgkmcnt(0)
ds_write_b128 v59, v[176:179] offset:0
ds_write_b128 v59, v[180:183] offset:1024
ds_write_b128 v59, v[184:187] offset:2048
ds_write_b128 v59, v[188:191] offset:3072
s_waitcnt lgkmcnt(0)
ds_read_b64_tr_b16 v[176:177], v7 offset:0
ds_read_b64_tr_b16 v[178:179], v7 offset:512
ds_read_b64_tr_b16 v[180:181], v7 offset:32
ds_read_b64_tr_b16 v[182:183], v7 offset:544
ds_read_b64_tr_b16 v[184:185], v7 offset:64
ds_read_b64_tr_b16 v[186:187], v7 offset:576
ds_read_b64_tr_b16 v[188:189], v7 offset:96
ds_read_b64_tr_b16 v[190:191], v7 offset:608
s_waitcnt lgkmcnt(0)
L_wo_xp_55:
s_mul_i32 s50, s48, 4608
s_add_u32 s50, s50, 458752
s_lshl_b32 s51, s47, 8
s_add_u32 s62, s50, s51
v_bfe_u32 v8, v1, 4, 1
v_mul_u32_u24 v20, 2304, v8
v_lshrrev_b32 v8, 5, v1
v_lshlrev_b32 v8, 4, v8
v_and_b32 v9, 15, v1
v_add_u32 v8, v8, v9
v_lshl_add_u32 v20, v8, 2, v20
v_add_u32 v20, s62, v20
s_mov_b32 s56, 0
s_mov_b32 s57, -1
s_lshr_b32 s50, s48, 2
s_bfe_u32 s51, s48, 0x10001
s_and_b32 s52, s48, 1
s_lshr_b32 s53, s47, 1
s_lshl_b32 s53, s53, 4
s_add_u32 s50, s50, s53
s_lshl_b32 s50, s50, 3
s_mul_i32 s50, s50, 1152
s_add_u32 s50, s50, 131072
v_lshrrev_b32 v8, 4, v1
v_mul_u32_u24 v8, 1152, v8
v_add_u32 v8, s50, v8
s_and_b32 s53, s47, 1
s_mul_i32 s55, s53, 4608
s_xor_b32 s53, s53, 1
s_mul_i32 s53, s53, 4608
s_lshl_b32 s50, s51, 3
s_add_u32 s55, s55, s50
s_add_u32 s53, s53, s50
v_add_u32 v22, s55, v8
v_add_u32 v25, s53, v8
s_sub_u32 s55, s55, s50
s_lshl_b32 s51, s51, 9
s_lshl_b32 s52, s52, 8
s_add_u32 s51, s51, s52
s_add_u32 s55, s55, s51
v_and_b32 v9, 15, v1
v_lshlrev_b32 v9, 4, v9
v_add_u32 v21, v8, v9
v_add_u32 v21, s55, v21
s_lshl_b32 s50, s47, 8
s_add_u32 s50, s50, 151552
v_add_u32 v24, s50, v9
v_bfe_u32 v8, v1, 2, 1
v_lshlrev_b32 v23, 9, v8
v_lshrrev_b32 v8, 4, v1
v_lshl_add_u32 v23, v8, 5, v23
v_add_u32 v23, 151552, v23
s_mov_b32 s54, 0x3fb8aa3b
v_mov_b32 v14, 0
L_wi_56:
s_add_u32 s73, s73, 1
s_cmp_gt_u32 s73, 400000
s_movk_i32 s74, 3
s_cbranch_scc1 L_fail
global_load_dword v15, v14, s[28:29] sc1
s_waitcnt vmcnt(0)
v_readfirstlane_b32 s50, v15
s_cmp_ge_u32 s50, 256
s_cbranch_scc0 L_wi_56
s_barrier
L_hopA_57:
global_load_dwordx4 v[32:35], v21, s[30:31] sc1
global_load_dwordx2 v[36:37], v22, s[30:31] offset:1024 sc1
global_load_dwordx2 v[38:39], v25, s[30:31] offset:1024 sc1
s_waitcnt vmcnt(0)
s_mov_b64 s[52:53], 0
v_cmp_eq_u32 vcc, -1, v32
s_or_b64 s[52:53], s[52:53], vcc
v_cmp_eq_u32 vcc, -1, v33
s_or_b64 s[52:53], s[52:53], vcc
v_cmp_eq_u32 vcc, -1, v34
s_or_b64 s[52:53], s[52:53], vcc
v_cmp_eq_u32 vcc, -1, v35
s_or_b64 s[52:53], s[52:53], vcc
v_cmp_eq_u32 vcc, -1, v36
s_or_b64 s[52:53], s[52:53], vcc
v_cmp_eq_u32 vcc, -1, v37
s_or_b64 s[52:53], s[52:53], vcc
v_cmp_eq_u32 vcc, -1, v38
s_or_b64 s[52:53], s[52:53], vcc
v_cmp_eq_u32 vcc, -1, v39
s_or_b64 s[52:53], s[52:53], vcc
s_add_u32 s73, s73, 1
s_cmp_gt_u32 s73, 400000
s_movk_i32 s74, 7
s_cbranch_scc1 L_fail
s_cmp_lg_u64 s[52:53], 0
s_cbranch_scc1 L_hopA_57
v_max_f32 v8, v36, v38
v_mov_b32 v9, v8
s_nop 1
v_permlane16_swap_b32 v9, v8
v_max_f32 v8, v8, v9
v_mov_b32 v9, v8
s_nop 1
v_permlane32_swap_b32 v9, v8
v_max_f32 v8, v8, v9
v_sub_f32 v36, v36, v8
v_sub_f32 v38, v38, v8
v_mul_f32 v36, s54, v36
v_mul_f32 v38, s54, v38
v_exp_f32 v36, v36
v_exp_f32 v38, v38
v_mul_f32 v10, v36, v37
v_mul_f32 v32, v36, v32
v_fmac_f32 v10, v38, v39
v_mul_f32 v33, v36, v33
v_mul_f32 v34, v36, v34
v_mul_f32 v35, v36, v35
v_mov_b32 v11, v10
v_mov_b32 v12, v32
v_mov_b32 v13, v33
v_mov_b32 v14, v34
v_mov_b32 v15, v35
v_permlane16_swap_b32 v11, v10
v_permlane16_swap_b32 v12, v32
v_permlane16_swap_b32 v13, v33
v_permlane16_swap_b32 v14, v34
v_permlane16_swap_b32 v15, v35
v_add_f32 v10, v10, v11
v_add_f32 v32, v32, v12
v_add_f32 v33, v33, v13
v_add_f32 v34, v34, v14
v_add_f32 v35, v35, v15
v_mov_b32 v11, v10
v_mov_b32 v12, v32
v_mov_b32 v13, v33
v_mov_b32 v14, v34
v_mov_b32 v15, v35
v_permlane32_swap_b32 v11, v10
v_permlane32_swap_b32 v12, v32
v_permlane32_swap_b32 v13, v33
v_permlane32_swap_b32 v14, v34
v_permlane32_swap_b32 v15, v35
v_add_f32 v10, v10, v11
v_add_f32 v32, v32, v12
v_add_f32 v33, v33, v13
v_add_f32 v34, v34, v14
v_add_f32 v35, v35, v15
v_rcp_f32 v10, v10
s_nop 0
v_mul_f32 v32, v32, v10
v_mul_f32 v33, v33, v10
v_mul_f32 v34, v34, v10
v_mul_f32 v35, v35, v10
ds_write_b128 v24, v[32:35]
s_waitcnt lgkmcnt(0)
s_barrier
ds_read_b128 v[32:35], v23 offset:0
ds_read_b128 v[36:39], v23 offset:16
ds_read_b128 v[40:43], v23 offset:256
ds_read_b128 v[44:47], v23 offset:272
ds_read_b128 v[48:51], v23 offset:128
ds_read_b128 v[52:55], v23 offset:144
ds_read_b128 v[56:59], v23 offset:384
ds_read_b128 v[60:63], v23 offset:400
s_waitcnt lgkmcnt(0)
v_add_f32 v32, v32, v40
v_add_f32 v33, v33, v41
v_add_f32 v34, v34, v42
v_add_f32 v35, v35, v43
v_add_f32 v36, v36, v44
v_add_f32 v37, v37, v45
v_add_f32 v38, v38, v46
v_add_f32 v39, v39, v47
v_cvt_pk_bf16_f32 v24, v32, v33
v_cvt_pk_bf16_f32 v25, v34, v35
v_cvt_pk_bf16_f32 v26, v36, v37
v_cvt_pk_bf16_f32 v27, v38, v39
v_add_f32 v48, v48, v56
v_add_f32 v49, v49, v57
v_add_f32 v50, v50, v58
v_add_f32 v51, v51, v59
v_add_f32 v52, v52, v60
v_add_f32 v53, v53, v61
v_add_f32 v54, v54, v62
v_add_f32 v55, v55, v63
v_cvt_pk_bf16_f32 v28, v48, v49
v_cvt_pk_bf16_f32 v29, v50, v51
v_cvt_pk_bf16_f32 v30, v52, v53
v_cvt_pk_bf16_f32 v31, v54, v55
v_mfma_f32_16x16x32_bf16 v[32:35], v[24:27], v[96:99], 0
s_nop 0
v_mfma_f32_16x16x32_bf16 v[32:35], v[28:31], v[112:115], v[32:35]
v_mfma_f32_16x16x32_bf16 v[36:39], v[24:27], v[100:103], 0
v_mfma_f32_16x16x32_bf16 v[36:39], v[28:31], v[116:119], v[36:39]
v_mfma_f32_16x16x32_bf16 v[40:43], v[24:27], v[104:107], 0
v_mfma_f32_16x16x32_bf16 v[40:43], v[28:31], v[120:123], v[40:43]
v_mfma_f32_16x16x32_bf16 v[44:47], v[24:27], v[108:111], 0
v_mfma_f32_16x16x32_bf16 v[44:47], v[28:31], v[124:127], v[44:47]
s_nop 7
v_cndmask_b32 v48, v32, v36, s[56:57]
v_min_u32 v48, -2, v48
global_store_dword v20, v48, s[30:31] offset:0 sc0 sc1
v_cndmask_b32 v49, v40, v44, s[56:57]
v_min_u32 v49, -2, v49
global_store_dword v20, v49, s[30:31] offset:128 sc0 sc1
L_wo_mk_58:
v_mfma_f32_16x16x32_bf16 v[32:35], v[24:27], v[128:131], 0
v_mfma_f32_16x16x32_bf16 v[32:35], v[28:31], v[144:147], v[32:35]
v_mfma_f32_16x16x32_bf16 v[36:39], v[24:27], v[132:135], 0
v_mfma_f32_16x16x32_bf16 v[36:39], v[28:31], v[148:151], v[36:39]
v_mfma_f32_16x16x32_bf16 v[40:43], v[24:27], v[136:139], 0
v_mfma_f32_16x16x32_bf16 v[40:43], v[28:31], v[152:155], v[40:43]
v_mfma_f32_16x16x32_bf16 v[44:47], v[24:27], v[140:143], 0
v_mfma_f32_16x16x32_bf16 v[44:47], v[28:31], v[156:159], v[44:47]
s_nop 7
v_cndmask_b32 v48, v32, v36, s[56:57]
v_min_u32 v48, -2, v48
global_store_dword v20, v48, s[30:31] offset:1024 sc0 sc1
v_cndmask_b32 v49, v40, v44, s[56:57]
v_min_u32 v49, -2, v49
global_store_dword v20, v49, s[30:31] offset:1152 sc0 sc1
L_wo_mk_59:
s_cmp_lg_u32 s47, 0
s_cbranch_scc1 L_wo_mk_60
v_mfma_f32_16x16x32_bf16 v[32:35], v[24:27], v[160:163], 0
v_mfma_f32_16x16x32_bf16 v[32:35], v[28:31], v[176:179], v[32:35]
v_mfma_f32_16x16x32_bf16 v[36:39], v[24:27], v[164:167], 0
v_mfma_f32_16x16x32_bf16 v[36:39], v[28:31], v[180:183], v[36:39]
v_mfma_f32_16x16x32_bf16 v[40:43], v[24:27], v[168:171], 0
v_mfma_f32_16x16x32_bf16 v[40:43], v[28:31], v[184:187], v[40:43]
v_mfma_f32_16x16x32_bf16 v[44:47], v[24:27], v[172:175], 0
v_mfma_f32_16x16x32_bf16 v[44:47], v[28:31], v[188:191], v[44:47]
s_nop 7
v_cndmask_b32 v48, v32, v36, s[56:57]
v_min_u32 v48, -2, v48
global_store_dword v20, v48, s[30:31] offset:2048 sc0 sc1
v_cndmask_b32 v49, v40, v44, s[56:57]
v_min_u32 v49, -2, v49
global_store_dword v20, v49, s[30:31] offset:2176 sc0 sc1
L_wo_mk_60:
s_branch L_hdone
L_red:
s_cmp_ge_u32 s48, 18
s_cselect_b32 s60, 1, 0
s_mul_i32 s50, s60, 18
s_sub_u32 s61, s48, s50
v_and_b32 v24, 31, v1
s_lshl_b32 s50, s61, 5
v_add_u32 v24, s50, v24
s_mul_i32 s51, s60, 1152
v_lshlrev_b32 v25, 1, v24
v_add_u32 v25, s51, v25
global_load_ushort v26, v25, s[4:5]
v_lshrrev_b32 v27, 4, v24
v_lshlrev_b32 v27, 7, v27
v_bfe_u32 v28, v24, 1, 3
v_lshl_add_u32 v27, v28, 3, v27
s_lshl_b32 s51, s60, 6
v_add_u32 v27, s51, v27
v_add_u32 v28, 13312, v27
v_add_u32 v29, 27136, v27
L_red_pp_61:
global_load_dwordx2 v[14:15], v28, s[30:31] sc1
global_load_dwordx2 v[16:17], v29, s[30:31] sc1
s_waitcnt vmcnt(0)
v_cmp_ne_u32 vcc, v15, v58
s_mov_b64 s[52:53], vcc
v_cmp_ne_u32 vcc, v17, v58
s_or_b64 s[52:53], s[52:53], vcc
s_add_u32 s73, s73, 1
s_cmp_gt_u32 s73, 400000
s_movk_i32 s74, 12
s_cbranch_scc1 L_fail
s_cmp_lg_u64 s[52:53], 0
s_cbranch_scc1 L_red_pp_61
v_and_b32 v8, 1, v24
v_cmp_eq_u32 vcc, 1, v8
v_lshlrev_b32 v9, 16, v14
v_and_b32 v10, 0xffff0000, v14
v_cndmask_b32 v21, v9, v10, vcc
v_lshlrev_b32 v9, 16, v16
v_and_b32 v10, 0xffff0000, v16
v_cndmask_b32 v22, v9, v10, vcc
v_lshlrev_b32 v23, 16, v26
s_lshl_b32 s50, s47, 1
v_lshrrev_b32 v8, 5, v1
v_add_u32 v8, s50, v8
v_mul_u32_u24 v18, 4608, v8
v_and_b32 v8, 31, v1
v_lshl_add_u32 v18, v8, 2, v18
s_lshl_b32 s50, s48, 7
s_add_u32 s50, s50, 786432
v_add_u32 v18, s50, v18
v_mov_b32 v14, 0
L_wi_62:
s_add_u32 s73, s73, 1
s_cmp_gt_u32 s73, 400000
s_movk_i32 s74, 3
s_cbranch_scc1 L_fail
global_load_dword v15, v14, s[28:29] sc1
s_waitcnt vmcnt(0)
v_readfirstlane_b32 s50, v15
s_cmp_ge_u32 s50, 256
s_cbranch_scc0 L_wi_62
s_barrier
s_lshl_b32 s50, s48, 7
s_add_u32 s50, s50, 458752
s_mul_i32 s51, s47, 36864
s_add_u32 s50, s50, s51
v_lshrrev_b32 v8, 3, v1
v_mul_u32_u24 v9, 4608, v8
v_and_b32 v8, 7, v1
v_lshl_add_u32 v9, v8, 4, v9
v_add_u32 v20, s50, v9
L_pollB_63:
v_add_u32 v9, 0, v20
global_load_dwordx4 v[32:35], v9, s[30:31] sc1
v_add_u32 v9, 147456, v20
global_load_dwordx4 v[36:39], v9, s[30:31] sc1
s_waitcnt vmcnt(0)
s_mov_b64 s[52:53], 0
v_cmp_eq_u32 vcc, -1, v32
s_or_b64 s[52:53], s[52:53], vcc
v_cmp_eq_u32 vcc, -1, v33
s_or_b64 s[52:53], s[52:53], vcc
v_cmp_eq_u32 vcc, -1, v34
s_or_b64 s[52:53], s[52:53], vcc
v_cmp_eq_u32 vcc, -1, v35
s_or_b64 s[52:53], s[52:53], vcc
v_cmp_eq_u32 vcc, -1, v36
s_or_b64 s[52:53], s[52:53], vcc
v_cmp_eq_u32 vcc, -1, v37
s_or_b64 s[52:53], s[52:53], vcc
v_cmp_eq_u32 vcc, -1, v38
s_or_b64 s[52:53], s[52:53], vcc
v_cmp_eq_u32 vcc, -1, v39
s_or_b64 s[52:53], s[52:53], vcc
s_add_u32 s73, s73, 1
s_cmp_gt_u32 s73, 400000
s_movk_i32 s74, 10
s_cbranch_scc1 L_fail
s_cmp_lg_u64 s[52:53], 0
s_cbranch_scc1 L_pollB_63
v_add_f32 v32, v32, v36
v_add_f32 v33, v33, v37
v_add_f32 v34, v34, v38
v_add_f32 v35, v35, v39
v_add_f32_dpp v32, v32, v32 row_ror:8 row_mask:0xf bank_mask:0xf
v_add_f32_dpp v33, v33, v33 row_ror:8 row_mask:0xf bank_mask:0xf
v_add_f32_dpp v34, v34, v34 row_ror:8 row_mask:0xf bank_mask:0xf
v_add_f32_dpp v35, v35, v35 row_ror:8 row_mask:0xf bank_mask:0xf
v_mov_b32 v10, v32
v_mov_b32 v11, v33
v_mov_b32 v12, v34
v_mov_b32 v13, v35
v_permlane16_swap_b32 v10, v32
v_permlane16_swap_b32 v11, v33
v_permlane16_swap_b32 v12, v34
v_permlane16_swap_b32 v13, v35
v_add_f32 v32, v32, v10
v_add_f32 v33, v33, v11
v_add_f32 v34, v34, v12
v_add_f32 v35, v35, v13
v_mov_b32 v10, v32
v_mov_b32 v11, v33
v_mov_b32 v12, v34
v_mov_b32 v13, v35
v_permlane32_swap_b32 v10, v32
v_permlane32_swap_b32 v11, v33
v_permlane32_swap_b32 v12, v34
v_permlane32_swap_b32 v13, v35
v_add_f32 v32, v32, v10
v_add_f32 v33, v33, v11
v_add_f32 v34, v34, v12
v_add_f32 v35, v35, v13
v_and_b32 v8, 7, v1
v_lshlrev_b32 v8, 4, v8
s_lshl_b32 s50, s47, 7
s_add_u32 s50, s50, 160896
v_add_u32 v8, s50, v8
s_mov_b64 exec, 0xff
ds_write_b128 v8, v[32:35]
s_mov_b64 exec, -1
s_waitcnt lgkmcnt(0)
s_barrier
v_and_b32 v9, 31, v1
v_lshlrev_b32 v9, 2, v9
v_add_u32 v9, 160896, v9
ds_read_b32 v8, v9
ds_read_b32 v10, v9 offset:128
ds_read_b32 v11, v9 offset:256
ds_read_b32 v12, v9 offset:384
s_waitcnt lgkmcnt(0)
v_add_f32 v8, v8, v10
v_add_f32 v11, v11, v12
v_add_f32 v8, v8, v11
v_cvt_pk_bf16_f32 v9, v8, v8
v_lshlrev_b32 v8, 16, v9
v_mul_f32 v8, v21, v8
v_cvt_pk_bf16_f32 v9, v8, v8
v_lshlrev_b32 v8, 16, v9
v_add_f32 v8, v23, v8
v_cvt_pk_bf16_f32 v9, v8, v8
v_lshlrev_b32 v8, 16, v9
v_mov_b32 v19, v8
global_store_dword v18, v19, s[30:31] sc0 sc1
s_lshl_b32 s50, s48, 7
s_add_u32 s50, s50, 851968
s_mul_i32 s51, s47, 36864
s_add_u32 s50, s50, s51
v_lshrrev_b32 v8, 3, v1
v_mul_u32_u24 v9, 4608, v8
v_and_b32 v8, 7, v1
v_lshl_add_u32 v9, v8, 4, v9
v_add_u32 v20, s50, v9
L_pollD_64:
v_add_u32 v9, 0, v20
global_load_dwordx4 v[32:35], v9, s[30:31] sc1
v_add_u32 v9, 147456, v20
global_load_dwordx4 v[36:39], v9, s[30:31] sc1
v_add_u32 v9, 294912, v20
global_load_dwordx4 v[40:43], v9, s[30:31] sc1
v_add_u32 v9, 442368, v20
global_load_dwordx4 v[44:47], v9, s[30:31] sc1
v_mov_b32 v48, 0
v_mov_b32 v49, 0
v_mov_b32 v50, 0
v_mov_b32 v51, 0
s_cmp_ge_u32 s47, 2
s_cbranch_scc1 L_rsk_65
v_add_u32 v9, 589824, v20
global_load_dwordx4 v[48:51], v9, s[30:31] sc1
L_rsk_65:
s_waitcnt vmcnt(0)
s_mov_b64 s[52:53], 0
v_cmp_eq_u32 vcc, -1, v32
s_or_b64 s[52:53], s[52:53], vcc
v_cmp_eq_u32 vcc, -1, v33
s_or_b64 s[52:53], s[52:53], vcc
v_cmp_eq_u32 vcc, -1, v34
s_or_b64 s[52:53], s[52:53], vcc
v_cmp_eq_u32 vcc, -1, v35
s_or_b64 s[52:53], s[52:53], vcc
v_cmp_eq_u32 vcc, -1, v36
s_or_b64 s[52:53], s[52:53], vcc
v_cmp_eq_u32 vcc, -1, v37
s_or_b64 s[52:53], s[52:53], vcc
v_cmp_eq_u32 vcc, -1, v38
s_or_b64 s[52:53], s[52:53], vcc
v_cmp_eq_u32 vcc, -1, v39
s_or_b64 s[52:53], s[52:53], vcc
v_cmp_eq_u32 vcc, -1, v40
s_or_b64 s[52:53], s[52:53], vcc
v_cmp_eq_u32 vcc, -1, v41
s_or_b64 s[52:53], s[52:53], vcc
v_cmp_eq_u32 vcc, -1, v42
s_or_b64 s[52:53], s[52:53], vcc
v_cmp_eq_u32 vcc, -1, v43
s_or_b64 s[52:53], s[52:53], vcc
v_cmp_eq_u32 vcc, -1, v44
s_or_b64 s[52:53], s[52:53], vcc
v_cmp_eq_u32 vcc, -1, v45
s_or_b64 s[52:53], s[52:53], vcc
v_cmp_eq_u32 vcc, -1, v46
s_or_b64 s[52:53], s[52:53], vcc
v_cmp_eq_u32 vcc, -1, v47
s_or_b64 s[52:53], s[52:53], vcc
v_cmp_eq_u32 vcc, -1, v48
s_or_b64 s[52:53], s[52:53], vcc
v_cmp_eq_u32 vcc, -1, v49
s_or_b64 s[52:53], s[52:53], vcc
v_cmp_eq_u32 vcc, -1, v50
s_or_b64 s[52:53], s[52:53], vcc
v_cmp_eq_u32 vcc, -1, v51
s_or_b64 s[52:53], s[52:53], vcc
s_add_u32 s73, s73, 1
s_cmp_gt_u32 s73, 400000
s_movk_i32 s74, 11
s_cbranch_scc1 L_fail
s_cmp_lg_u64 s[52:53], 0
s_cbranch_scc1 L_pollD_64
v_add_f32 v32, v32, v36
v_add_f32 v32, v32, v40
v_add_f32 v32, v32, v44
v_add_f32 v32, v32, v48
v_add_f32 v33, v33, v37
v_add_f32 v33, v33, v41
v_add_f32 v33, v33, v45
v_add_f32 v33, v33, v49
v_add_f32 v34, v34, v38
v_add_f32 v34, v34, v42
v_add_f32 v34, v34, v46
v_add_f32 v34, v34, v50
v_add_f32 v35, v35, v39
v_add_f32 v35, v35, v43
v_add_f32 v35, v35, v47
v_add_f32 v35, v35, v51
v_add_f32_dpp v32, v32, v32 row_ror:8 row_mask:0xf bank_mask:0xf
v_add_f32_dpp v33, v33, v33 row_ror:8 row_mask:0xf bank_mask:0xf
v_add_f32_dpp v34, v34, v34 row_ror:8 row_mask:0xf bank_mask:0xf
v_add_f32_dpp v35, v35, v35 row_ror:8 row_mask:0xf bank_mask:0xf
v_mov_b32 v10, v32
v_mov_b32 v11, v33
v_mov_b32 v12, v34
v_mov_b32 v13, v35
v_permlane16_swap_b32 v10, v32
v_permlane16_swap_b32 v11, v33
v_permlane16_swap_b32 v12, v34
v_permlane16_swap_b32 v13, v35
v_add_f32 v32, v32, v10
v_add_f32 v33, v33, v11
v_add_f32 v34, v34, v12
v_add_f32 v35, v35, v13
v_mov_b32 v10, v32
v_mov_b32 v11, v33
v_mov_b32 v12, v34
v_mov_b32 v13, v35
v_permlane32_swap_b32 v10, v32
v_permlane32_swap_b32 v11, v33
v_permlane32_swap_b32 v12, v34
v_permlane32_swap_b32 v13, v35
v_add_f32 v32, v32, v10
v_add_f32 v33, v33, v11
v_add_f32 v34, v34, v12
v_add_f32 v35, v35, v13
v_and_b32 v8, 7, v1
v_lshlrev_b32 v8, 4, v8
s_lshl_b32 s50, s47, 7
s_add_u32 s50, s50, 161408
v_add_u32 v8, s50, v8
s_mov_b64 exec, 0xff
ds_write_b128 v8, v[32:35]
s_mov_b64 exec, -1
s_waitcnt lgkmcnt(0)
s_barrier
v_and_b32 v9, 31, v1
v_lshlrev_b32 v9, 2, v9
v_add_u32 v9, 161408, v9
ds_read_b32 v8, v9
ds_read_b32 v10, v9 offset:128
ds_read_b32 v11, v9 offset:256
ds_read_b32 v12, v9 offset:384
s_waitcnt lgkmcnt(0)
v_add_f32 v8, v8, v10
v_add_f32 v11, v11, v12
v_add_f32 v8, v8, v11
v_cvt_pk_bf16_f32 v9, v8, v8
v_lshlrev_b32 v8, 16, v9
v_mul_f32 v8, v22, v8
v_cvt_pk_bf16_f32 v9, v8, v8
v_lshlrev_b32 v8, 16, v9
v_add_f32 v8, v19, v8
s_cmp_eq_u32 s47, 0
s_cbranch_scc0 L_red_n2
v_mov_b32_dpp v9, v8 quad_perm:[1,0,3,2] row_mask:0xf bank_mask:0xf
v_cvt_pk_bf16_f32 v10, v8, v9
s_mul_i32 s50, s60, 1152
s_lshl_b32 s51, s61, 6
s_add_u32 s50, s50, s51
v_lshlrev_b32 v9, 1, v1
v_add_u32 v9, s50, v9
s_mov_b32 s50, 0x55555555
s_mov_b32 s51, 0
s_mov_b64 exec, s[50:51]
global_store_dword v9, v10, s[26:27]
s_cmp_eq_u32 s48, 0
s_cbranch_scc0 L_red_n3
s_mov_b64 exec, 1
v_mov_b32 v9, 0
global_store_dword v9, v58, s[30:31] sc0 sc1
L_red_n3:
s_mov_b64 exec, -1
L_red_n2:
L_hdone:
s_endpgm
L_streamer:
s_getpc_b64 s[40:41]
L_pc:
s_sub_u32 s40, s40, L_pc-adaLN_cond__gqa_block_cached__swiglu_ffn__decode_kernel
s_subb_u32 s41, s41, 0
s_cmp_eq_u32 s3, 3
s_cbranch_scc0 L_nopf
v_lshlrev_b32 v20, 7, v1
v_min_u32 v21, L_exit-adaLN_cond__gqa_block_cached__swiglu_ffn__decode_kernel, v20
global_load_dword v200, v21, s[40:41]
v_add_u32 v20, 8192, v20
v_min_u32 v21, L_exit-adaLN_cond__gqa_block_cached__swiglu_ffn__decode_kernel, v20
global_load_dword v200, v21, s[40:41]
v_add_u32 v20, 8192, v20
v_min_u32 v21, L_exit-adaLN_cond__gqa_block_cached__swiglu_ffn__decode_kernel, v20
global_load_dword v200, v21, s[40:41]
v_add_u32 v20, 8192, v20
v_min_u32 v21, L_exit-adaLN_cond__gqa_block_cached__swiglu_ffn__decode_kernel, v20
global_load_dword v200, v21, s[40:41]
v_add_u32 v20, 8192, v20
L_nopf:
v_lshrrev_b32 v20, 4, v1
v_and_b32 v21, 15, v1
v_xor_b32 v22, v21, v20
v_lshlrev_b32 v22, 4, v22
v_lshlrev_b32 v23, 8, v20
v_xor_b32 v24, 0, v22
v_add_u32 v2, v23, v24
v_xor_b32 v24, 64, v22
v_add_u32 v3, v23, v24
v_xor_b32 v24, 128, v22
v_add_u32 v4, v23, v24
v_xor_b32 v24, 192, v22
v_add_u32 v5, v23, v24
v_or_b32 v24, 0, v20
v_lshlrev_b32 v24, 1, v24
v_xor_b32 v24, v21, v24
v_lshlrev_b32 v24, 4, v24
v_add_u32 v6, v23, v24
v_or_b32 v24, 4, v20
v_lshlrev_b32 v24, 1, v24
v_xor_b32 v24, v21, v24
v_lshlrev_b32 v24, 4, v24
v_add_u32 v7, v23, v24
s_mul_i32 s45, s3, 32768
v_lshlrev_b32 v25, 8, v21
v_add_u32 v25, s45, v25
v_xor_b32 v24, 0, v22
v_add_u32 v8, v25, v24
v_xor_b32 v24, 64, v22
v_add_u32 v9, v25, v24
v_xor_b32 v24, 128, v22
v_add_u32 v10, v25, v24
v_xor_b32 v24, 192, v22
v_add_u32 v11, v25, v24
v_lshrrev_b32 v26, 2, v21
v_lshl_add_u32 v26, v20, 2, v26
v_and_b32 v27, 7, v26
v_lshlrev_b32 v27, 5, v27
v_lshlrev_b32 v26, 8, v26
v_and_b32 v28, 3, v21
v_lshl_add_u32 v26, v28, 3, v26
v_add_u32 v26, s45, v26
v_add_u32 v26, 4096, v26
v_xor_b32 v24, 0, v27
v_add_u32 v12, v26, v24
v_xor_b32 v24, 32, v27
v_add_u32 v13, v26, v24
v_xor_b32 v24, 64, v27
v_add_u32 v14, v26, v24
v_xor_b32 v24, 96, v27
v_add_u32 v15, v26, v24
v_xor_b32 v24, 128, v27
v_add_u32 v16, v26, v24
v_xor_b32 v24, 160, v27
v_add_u32 v17, v26, v24
v_xor_b32 v24, 192, v27
v_add_u32 v18, v26, v24
v_xor_b32 v24, 224, v27
v_add_u32 v19, v26, v24
s_and_b32 s47, s2, 7
s_lshl_b32 s53, s47, 2
s_add_u32 s44, s53, s3
s_waitcnt lgkmcnt(0)
s_and_b32 s65, s67, 3
s_bfe_u32 s46, s67, 0x50014
s_mul_i32 s63, s46, 3
s_lshl_b32 s64, s46, 3
s_add_u32 s64, s64, s47
s_lshl_b32 s48, s46, 8
s_add_u32 s48, s48, 1572864
v_mov_b32 v119, s48
s_lshl_b32 s48, s46, 22
s_add_u32 s32, s6, s48
s_addc_u32 s33, s7, 0
s_and_b32 s33, s33, 0xffff
s_mov_b32 s34, 0x400000
s_mov_b32 s35, 0x20000
s_add_u32 s36, s8, s48
s_addc_u32 s37, s9, 0
s_and_b32 s37, s37, 0xffff
s_mov_b32 s38, 0x400000
s_mov_b32 s39, 0x20000
s_barrier
s_mov_b32 s58, 161940
s_mov_b32 s59, 4
v_mov_b32 v115, s58
L_gate_66:
s_add_u32 s73, s73, 1
s_cmp_gt_u32 s73, 400000
s_movk_i32 s74, 15
s_cbranch_scc1 L_fail
s_sleep 1
ds_read_b32 v114, v115
s_waitcnt lgkmcnt(0)
v_readfirstlane_b32 s53, v114
s_cmp_ge_u32 s53, s59
s_cbranch_scc0 L_gate_66
L_gated_67:
s_add_u32 s49, s44, 0
s_add_u32 s49, s49, s63
s_and_b32 s49, s49, 1023
s_lshl_b32 s49, s49, 12
s_add_u32 m0, s45, 0
s_nop 0
buffer_load_dwordx4 v2, s[32:35], s49 offen offset:0 nt lds
buffer_load_dwordx4 v3, s[32:35], s49 offen offset:1024 nt lds
buffer_load_dwordx4 v4, s[32:35], s49 offen offset:2048 nt lds
buffer_load_dwordx4 v5, s[32:35], s49 offen offset:3072 nt lds
s_add_u32 m0, s45, 4096
s_nop 0
buffer_load_dwordx4 v6, s[36:39], s49 offen offset:0 nt lds
buffer_load_dwordx4 v7, s[36:39], s49 offen offset:1024 nt lds
buffer_load_dwordx4 v6, s[36:39], s49 offen offset:2048 nt lds
buffer_load_dwordx4 v7, s[36:39], s49 offen offset:3072 nt lds
s_add_u32 s49, s44, 32
s_add_u32 s49, s49, s63
s_and_b32 s49, s49, 1023
s_lshl_b32 s49, s49, 12
s_cmp_eq_u32 s65, 0
s_cbranch_scc0 L_pw_68
s_waitcnt vmcnt(4)
L_pw_68:
s_add_u32 m0, s45, 8192
s_nop 0
buffer_load_dwordx4 v2, s[32:35], s49 offen offset:0 nt lds
buffer_load_dwordx4 v3, s[32:35], s49 offen offset:1024 nt lds
buffer_load_dwordx4 v4, s[32:35], s49 offen offset:2048 nt lds
buffer_load_dwordx4 v5, s[32:35], s49 offen offset:3072 nt lds
s_cmp_eq_u32 s65, 0
s_cbranch_scc0 L_pw_69
s_waitcnt vmcnt(4)
L_pw_69:
s_add_u32 m0, s45, 12288
s_nop 0
buffer_load_dwordx4 v6, s[36:39], s49 offen offset:0 nt lds
buffer_load_dwordx4 v7, s[36:39], s49 offen offset:1024 nt lds
buffer_load_dwordx4 v6, s[36:39], s49 offen offset:2048 nt lds
buffer_load_dwordx4 v7, s[36:39], s49 offen offset:3072 nt lds
s_add_u32 s49, s44, 64
s_add_u32 s49, s49, s63
s_and_b32 s49, s49, 1023
s_lshl_b32 s49, s49, 12
s_cmp_eq_u32 s65, 0
s_cbranch_scc0 L_pw_70
s_waitcnt vmcnt(4)
L_pw_70:
s_add_u32 m0, s45, 16384
s_nop 0
buffer_load_dwordx4 v2, s[32:35], s49 offen offset:0 nt lds
buffer_load_dwordx4 v3, s[32:35], s49 offen offset:1024 nt lds
buffer_load_dwordx4 v4, s[32:35], s49 offen offset:2048 nt lds
buffer_load_dwordx4 v5, s[32:35], s49 offen offset:3072 nt lds
s_cmp_eq_u32 s65, 0
s_cbranch_scc0 L_pw_71
s_waitcnt vmcnt(4)
L_pw_71:
s_add_u32 m0, s45, 20480
s_nop 0
buffer_load_dwordx4 v6, s[36:39], s49 offen offset:0 nt lds
buffer_load_dwordx4 v7, s[36:39], s49 offen offset:1024 nt lds
buffer_load_dwordx4 v6, s[36:39], s49 offen offset:2048 nt lds
buffer_load_dwordx4 v7, s[36:39], s49 offen offset:3072 nt lds
s_add_u32 s49, s44, 96
s_add_u32 s49, s49, s63
s_and_b32 s49, s49, 1023
s_lshl_b32 s49, s49, 12
s_cmp_eq_u32 s65, 0
s_cbranch_scc0 L_pw_72
s_waitcnt vmcnt(4)
L_pw_72:
s_add_u32 m0, s45, 24576
s_nop 0
buffer_load_dwordx4 v2, s[32:35], s49 offen offset:0 nt lds
buffer_load_dwordx4 v3, s[32:35], s49 offen offset:1024 nt lds
buffer_load_dwordx4 v4, s[32:35], s49 offen offset:2048 nt lds
buffer_load_dwordx4 v5, s[32:35], s49 offen offset:3072 nt lds
s_cmp_eq_u32 s65, 0
s_cbranch_scc0 L_pw_73
s_waitcnt vmcnt(4)
L_pw_73:
s_add_u32 m0, s45, 28672
s_nop 0
buffer_load_dwordx4 v6, s[36:39], s49 offen offset:0 nt lds
buffer_load_dwordx4 v7, s[36:39], s49 offen offset:1024 nt lds
buffer_load_dwordx4 v6, s[36:39], s49 offen offset:2048 nt lds
buffer_load_dwordx4 v7, s[36:39], s49 offen offset:3072 nt lds
s_mov_b32 s50, 0x3db504f3
s_mov_b32 s51, 0x3fb8aa3b
s_mov_b32 s52, 0xbfb8aa3b
v_mov_b32 v112, 0xff800000
v_mov_b32 v113, 0
v_mov_b32 v80, 0
v_mov_b32 v81, 0
v_mov_b32 v82, 0
v_mov_b32 v83, 0
v_mov_b32 v84, 0
v_mov_b32 v85, 0
v_mov_b32 v86, 0
v_mov_b32 v87, 0
v_mov_b32 v88, 0
v_mov_b32 v89, 0
v_mov_b32 v90, 0
v_mov_b32 v91, 0
v_mov_b32 v92, 0
v_mov_b32 v93, 0
v_mov_b32 v94, 0
v_mov_b32 v95, 0
v_mov_b32 v96, 0
v_mov_b32 v97, 0
v_mov_b32 v98, 0
v_mov_b32 v99, 0
v_mov_b32 v100, 0
v_mov_b32 v101, 0
v_mov_b32 v102, 0
v_mov_b32 v103, 0
v_mov_b32 v104, 0
v_mov_b32 v105, 0
v_mov_b32 v106, 0
v_mov_b32 v107, 0
v_mov_b32 v108, 0
v_mov_b32 v109, 0
v_mov_b32 v110, 0
v_mov_b32 v111, 0
s_add_u32 s53, s44, 192
v_mov_b32 v120, s53
s_add_u32 s53, s44, 224
v_mov_b32 v121, s53
v_mov_b32 v115, 161924
L_wq_74:
s_add_u32 s73, s73, 1
s_cmp_gt_u32 s73, 400000
s_movk_i32 s74, 4
s_cbranch_scc1 L_fail
s_sleep 1
ds_read_b32 v114, v115
s_waitcnt lgkmcnt(0)
v_readfirstlane_b32 s53, v114
s_cmp_eq_u32 s53, 1
s_cbranch_scc0 L_wq_74
v_and_b32 v114, 1, v1
v_lshlrev_b32 v114, 8, v114
v_lshrrev_b32 v115, 4, v1
v_lshl_add_u32 v114, v115, 4, v114
v_add_u32 v114, 156160, v114
ds_read_b128 v[20:23], v114 offset:0
ds_read_b128 v[24:27], v114 offset:64
ds_read_b128 v[28:31], v114 offset:128
ds_read_b128 v[32:35], v114 offset:192
s_waitcnt lgkmcnt(0)
s_mul_i32 s53, s3, 1056
s_add_u32 s53, s53, 156672
v_and_b32 v114, 1, v1
v_lshlrev_b32 v122, 9, v114
v_lshrrev_b32 v116, 4, v1
v_lshl_add_u32 v122, v116, 4, v122
v_add_u32 v122, s53, v122
v_lshlrev_b32 v123, 3, v114
v_add_u32 v123, s53, v123
v_lshrrev_b32 v114, 5, v1
v_and_b32 v116, 31, v1
v_lshlrev_b32 v124, 9, v114
v_lshl_add_u32 v124, v116, 4, v124
v_add_u32 v124, 156672, v124
v_lshlrev_b32 v125, 3, v114
v_add_u32 v127, 131072, v125
v_add_u32 v125, 157696, v125
s_mul_i32 s53, s64, 1152
v_lshlrev_b32 v126, 4, v1
v_add_u32 v126, s53, v126
v_add_u32 v126, 131072, v126
v_add_u32 v127, s53, v127
s_mov_b32 s42, 0x00030003
s_mov_b32 s43, 0x00030003
s_mov_b32 s58, 0
s_mov_b32 s54, 0
s_mov_b32 s56, 0
s_mov_b32 s57, 0
L_sloop:
s_cmp_lg_u32 s56, 0
s_cbranch_scc1 L_w0_76
s_cmp_eq_u32 s54, 0
s_cbranch_scc1 L_w1_77
s_cmp_eq_u32 s54, 1
s_cbranch_scc1 L_w2_78
s_cmp_gt_u32 s58, 20
s_cbranch_scc1 L_sw_83
s_waitcnt vmcnt(8)
s_branch L_is_82
L_sw_83:
s_waitcnt vmcnt(9)
s_branch L_is_82
L_w2_78:
s_waitcnt vmcnt(8)
s_branch L_is_82
L_w1_77:
s_waitcnt vmcnt(24)
s_branch L_go_75
L_is_82:
v_readfirstlane_b32 s53, v120
s_cmp_ge_u32 s53, 1024
s_cbranch_scc1 L_dr_81
s_add_u32 s49, s53, s63
s_and_b32 s49, s49, 1023
s_lshl_b32 s49, s49, 12
s_add_u32 m0, s45, 16384
s_nop 0
buffer_load_dwordx4 v2, s[32:35], s49 offen offset:0 nt lds
buffer_load_dwordx4 v3, s[32:35], s49 offen offset:1024 nt lds
buffer_load_dwordx4 v4, s[32:35], s49 offen offset:2048 nt lds
buffer_load_dwordx4 v5, s[32:35], s49 offen offset:3072 nt lds
s_add_u32 m0, s45, 20480
s_nop 0
buffer_load_dwordx4 v6, s[36:39], s49 offen offset:0 nt lds
buffer_load_dwordx4 v7, s[36:39], s49 offen offset:1024 nt lds
buffer_load_dwordx4 v6, s[36:39], s49 offen offset:2048 nt lds
buffer_load_dwordx4 v7, s[36:39], s49 offen offset:3072 nt lds
s_cmp_lt_u32 s58, 20
s_cbranch_scc1 L_st_84
v_mov_b32 v120, 1
s_mov_b64 exec, 1
global_atomic_add v120, v119, v120, s[30:31] sc0 sc1
s_mov_b64 exec, -1
s_branch L_sd_85
L_st_84:
v_add_u32 v120, 64, v120
L_sd_85:
s_branch L_go_75
L_dr_81:
s_mov_b32 s56, 1
s_mov_b32 s57, 2
s_branch L_go_75
L_w0_76:
s_waitcnt vmcnt(0)
L_go_75:
ds_read_b128 v[36:39], v8 offset:0
ds_read_b128 v[40:43], v9 offset:0
ds_read_b128 v[44:47], v10 offset:0
ds_read_b128 v[48:51], v11 offset:0
ds_read_b64_tr_b16 v[52:53], v12 offset:0
ds_read_b64_tr_b16 v[54:55], v13 offset:0
ds_read_b64_tr_b16 v[56:57], v14 offset:0
ds_read_b64_tr_b16 v[58:59], v15 offset:0
ds_read_b64_tr_b16 v[60:61], v16 offset:0
ds_read_b64_tr_b16 v[62:63], v17 offset:0
ds_read_b64_tr_b16 v[64:65], v18 offset:0
ds_read_b64_tr_b16 v[66:67], v19 offset:0
s_waitcnt lgkmcnt(8)
v_mfma_f32_16x16x32_bf16 v[68:71], v[36:39], v[20:23], 0
v_mfma_f32_16x16x32_bf16 v[68:71], v[40:43], v[24:27], v[68:71]
v_mfma_f32_16x16x32_bf16 v[68:71], v[44:47], v[28:31], v[68:71]
v_mfma_f32_16x16x32_bf16 v[68:71], v[48:51], v[32:35], v[68:71]
s_waitcnt lgkmcnt(0)
s_cmp_eq_u32 s54, 0
s_cbranch_scc0 L_ni_79
s_add_u32 s49, s44, 128
s_add_u32 s49, s49, s63
s_and_b32 s49, s49, 1023
s_lshl_b32 s49, s49, 12
s_add_u32 m0, s45, 0
s_nop 0
buffer_load_dwordx4 v2, s[32:35], s49 offen offset:0 nt lds
buffer_load_dwordx4 v3, s[32:35], s49 offen offset:1024 nt lds
buffer_load_dwordx4 v4, s[32:35], s49 offen offset:2048 nt lds
buffer_load_dwordx4 v5, s[32:35], s49 offen offset:3072 nt lds
s_add_u32 m0, s45, 4096
s_nop 0
buffer_load_dwordx4 v6, s[36:39], s49 offen offset:0 nt lds
buffer_load_dwordx4 v7, s[36:39], s49 offen offset:1024 nt lds
buffer_load_dwordx4 v6, s[36:39], s49 offen offset:2048 nt lds
buffer_load_dwordx4 v7, s[36:39], s49 offen offset:3072 nt lds
L_ni_79:
s_nop 7
v_cvt_pk_bf16_f32 v76, v68, v69
v_cvt_pk_bf16_f32 v77, v70, v71
v_lshlrev_b32 v72, 16, v76
v_and_b32 v73, 0xffff0000, v76
v_lshlrev_b32 v74, 16, v77
v_and_b32 v75, 0xffff0000, v77
v_mul_f32 v72, s50, v72
v_mul_f32 v73, s50, v73
v_mul_f32 v74, s50, v74
v_mul_f32 v75, s50, v75
v_cvt_pk_bf16_f32 v76, v72, v73
v_cvt_pk_bf16_f32 v77, v74, v75
v_lshlrev_b32 v72, 16, v76
v_and_b32 v73, 0xffff0000, v76
v_lshlrev_b32 v74, 16, v77
v_and_b32 v75, 0xffff0000, v77
v_max3_f32 v114, v72, v73, v74
v_max_f32 v114, v114, v75
v_mov_b32 v115, v114
s_nop 1
v_permlane16_swap_b32 v115, v114
v_max_f32 v114, v114, v115
v_mov_b32 v115, v114
s_nop 1
v_permlane32_swap_b32 v115, v114
v_max_f32 v114, v114, v115
v_max_f32 v114, v114, v112
v_cmp_gt_f32 vcc, v114, v112
s_cbranch_vccz L_nr_86
v_sub_f32 v116, v112, v114
v_mul_f32 v116, s51, v116
v_exp_f32 v116, v116
v_mov_b32 v112, v114
v_mul_f32 v113, v113, v116
v_pk_mul_f32 v[80:81], v[80:81], v[116:117] op_sel_hi:[1,0]
v_pk_mul_f32 v[82:83], v[82:83], v[116:117] op_sel_hi:[1,0]
v_pk_mul_f32 v[84:85], v[84:85], v[116:117] op_sel_hi:[1,0]
v_pk_mul_f32 v[86:87], v[86:87], v[116:117] op_sel_hi:[1,0]
v_pk_mul_f32 v[88:89], v[88:89], v[116:117] op_sel_hi:[1,0]
v_pk_mul_f32 v[90:91], v[90:91], v[116:117] op_sel_hi:[1,0]
v_pk_mul_f32 v[92:93], v[92:93], v[116:117] op_sel_hi:[1,0]
v_pk_mul_f32 v[94:95], v[94:95], v[116:117] op_sel_hi:[1,0]
v_pk_mul_f32 v[96:97], v[96:97], v[116:117] op_sel_hi:[1,0]
v_pk_mul_f32 v[98:99], v[98:99], v[116:117] op_sel_hi:[1,0]
v_pk_mul_f32 v[100:101], v[100:101], v[116:117] op_sel_hi:[1,0]
v_pk_mul_f32 v[102:103], v[102:103], v[116:117] op_sel_hi:[1,0]
v_pk_mul_f32 v[104:105], v[104:105], v[116:117] op_sel_hi:[1,0]
v_pk_mul_f32 v[106:107], v[106:107], v[116:117] op_sel_hi:[1,0]
v_pk_mul_f32 v[108:109], v[108:109], v[116:117] op_sel_hi:[1,0]
v_pk_mul_f32 v[110:111], v[110:111], v[116:117] op_sel_hi:[1,0]
L_nr_86:
v_mul_f32 v118, s52, v112
v_fma_f32 v72, v72, s51, v118
v_fma_f32 v73, v73, s51, v118
v_fma_f32 v74, v74, s51, v118
v_fma_f32 v75, v75, s51, v118
v_exp_f32 v72, v72
v_exp_f32 v73, v73
v_exp_f32 v74, v74
v_exp_f32 v75, v75
v_cvt_pk_bf16_f32 v78, v72, v73
v_cvt_pk_bf16_f32 v79, v74, v75
v_add_f32 v72, v72, v73
v_add_f32 v74, v74, v75
v_add_f32 v72, v72, v74
v_add_f32 v113, v113, v72
v_mfma_f32_16x16x16_bf16 v[80:83], v[52:53], v[78:79], v[80:83]
v_mfma_f32_16x16x16_bf16 v[84:87], v[54:55], v[78:79], v[84:87]
v_mfma_f32_16x16x16_bf16 v[88:91], v[56:57], v[78:79], v[88:91]
v_mfma_f32_16x16x16_bf16 v[92:95], v[58:59], v[78:79], v[92:95]
v_mfma_f32_16x16x16_bf16 v[96:99], v[60:61], v[78:79], v[96:99]
v_mfma_f32_16x16x16_bf16 v[100:103], v[62:63], v[78:79], v[100:103]
v_mfma_f32_16x16x16_bf16 v[104:107], v[64:65], v[78:79], v[104:107]
v_mfma_f32_16x16x16_bf16 v[108:111], v[66:67], v[78:79], v[108:111]
s_add_u32 s58, s58, 1
s_cmp_eq_u32 s56, 0
s_cbranch_scc1 L_ct_87
s_sub_u32 s57, s57, 1
s_cmp_eq_u32 s57, 0
s_cbranch_scc1 L_sdrained
L_ct_87:
s_cmp_lg_u32 s56, 0
s_cbranch_scc1 L_w0_89
s_cmp_eq_u32 s54, 0
s_cbranch_scc1 L_w1_90
s_cmp_gt_u32 s58, 20
s_cbranch_scc1 L_sw_96
s_waitcnt vmcnt(8)
s_branch L_is_95
L_sw_96:
s_waitcnt vmcnt(9)
s_branch L_is_95
L_w1_90:
s_waitcnt vmcnt(24)
s_branch L_go_88
L_is_95:
v_readfirstlane_b32 s53, v121
s_cmp_ge_u32 s53, 1024
s_cbranch_scc1 L_dr_94
s_add_u32 s49, s53, s63
s_and_b32 s49, s49, 1023
s_lshl_b32 s49, s49, 12
s_add_u32 m0, s45, 24576
s_nop 0
buffer_load_dwordx4 v2, s[32:35], s49 offen offset:0 nt lds
buffer_load_dwordx4 v3, s[32:35], s49 offen offset:1024 nt lds
buffer_load_dwordx4 v4, s[32:35], s49 offen offset:2048 nt lds
buffer_load_dwordx4 v5, s[32:35], s49 offen offset:3072 nt lds
s_add_u32 m0, s45, 28672
s_nop 0
buffer_load_dwordx4 v6, s[36:39], s49 offen offset:0 nt lds
buffer_load_dwordx4 v7, s[36:39], s49 offen offset:1024 nt lds
buffer_load_dwordx4 v6, s[36:39], s49 offen offset:2048 nt lds
buffer_load_dwordx4 v7, s[36:39], s49 offen offset:3072 nt lds
s_cmp_lt_u32 s58, 20
s_cbranch_scc1 L_st_97
v_mov_b32 v121, 1
s_mov_b64 exec, 1
global_atomic_add v121, v119, v121, s[30:31] sc0 sc1
s_mov_b64 exec, -1
s_branch L_sd_98
L_st_97:
v_add_u32 v121, 64, v121
L_sd_98:
s_branch L_go_88
L_dr_94:
s_mov_b32 s56, 1
s_mov_b32 s57, 2
s_branch L_go_88
L_w0_89:
s_waitcnt vmcnt(0)
L_go_88:
ds_read_b128 v[36:39], v8 offset:8192
ds_read_b128 v[40:43], v9 offset:8192
ds_read_b128 v[44:47], v10 offset:8192
ds_read_b128 v[48:51], v11 offset:8192
ds_read_b64_tr_b16 v[52:53], v12 offset:8192
ds_read_b64_tr_b16 v[54:55], v13 offset:8192
ds_read_b64_tr_b16 v[56:57], v14 offset:8192
ds_read_b64_tr_b16 v[58:59], v15 offset:8192
ds_read_b64_tr_b16 v[60:61], v16 offset:8192
ds_read_b64_tr_b16 v[62:63], v17 offset:8192
ds_read_b64_tr_b16 v[64:65], v18 offset:8192
ds_read_b64_tr_b16 v[66:67], v19 offset:8192
s_waitcnt lgkmcnt(8)
v_mfma_f32_16x16x32_bf16 v[68:71], v[36:39], v[20:23], 0
v_mfma_f32_16x16x32_bf16 v[68:71], v[40:43], v[24:27], v[68:71]
v_mfma_f32_16x16x32_bf16 v[68:71], v[44:47], v[28:31], v[68:71]
v_mfma_f32_16x16x32_bf16 v[68:71], v[48:51], v[32:35], v[68:71]
s_waitcnt lgkmcnt(0)
s_cmp_eq_u32 s54, 0
s_cbranch_scc0 L_ni_92
s_add_u32 s49, s44, 160
s_add_u32 s49, s49, s63
s_and_b32 s49, s49, 1023
s_lshl_b32 s49, s49, 12
s_add_u32 m0, s45, 8192
s_nop 0
buffer_load_dwordx4 v2, s[32:35], s49 offen offset:0 nt lds
buffer_load_dwordx4 v3, s[32:35], s49 offen offset:1024 nt lds
buffer_load_dwordx4 v4, s[32:35], s49 offen offset:2048 nt lds
buffer_load_dwordx4 v5, s[32:35], s49 offen offset:3072 nt lds
s_add_u32 m0, s45, 12288
s_nop 0
buffer_load_dwordx4 v6, s[36:39], s49 offen offset:0 nt lds
buffer_load_dwordx4 v7, s[36:39], s49 offen offset:1024 nt lds
buffer_load_dwordx4 v6, s[36:39], s49 offen offset:2048 nt lds
buffer_load_dwordx4 v7, s[36:39], s49 offen offset:3072 nt lds
L_ni_92:
s_nop 7
v_cvt_pk_bf16_f32 v76, v68, v69
v_cvt_pk_bf16_f32 v77, v70, v71
v_lshlrev_b32 v72, 16, v76
v_and_b32 v73, 0xffff0000, v76
v_lshlrev_b32 v74, 16, v77
v_and_b32 v75, 0xffff0000, v77
v_mul_f32 v72, s50, v72
v_mul_f32 v73, s50, v73
v_mul_f32 v74, s50, v74
v_mul_f32 v75, s50, v75
v_cvt_pk_bf16_f32 v76, v72, v73
v_cvt_pk_bf16_f32 v77, v74, v75
v_lshlrev_b32 v72, 16, v76
v_and_b32 v73, 0xffff0000, v76
v_lshlrev_b32 v74, 16, v77
v_and_b32 v75, 0xffff0000, v77
v_max3_f32 v114, v72, v73, v74
v_max_f32 v114, v114, v75
v_mov_b32 v115, v114
s_nop 1
v_permlane16_swap_b32 v115, v114
v_max_f32 v114, v114, v115
v_mov_b32 v115, v114
s_nop 1
v_permlane32_swap_b32 v115, v114
v_max_f32 v114, v114, v115
v_max_f32 v114, v114, v112
v_cmp_gt_f32 vcc, v114, v112
s_cbranch_vccz L_nr_99
v_sub_f32 v116, v112, v114
v_mul_f32 v116, s51, v116
v_exp_f32 v116, v116
v_mov_b32 v112, v114
v_mul_f32 v113, v113, v116
v_pk_mul_f32 v[80:81], v[80:81], v[116:117] op_sel_hi:[1,0]
v_pk_mul_f32 v[82:83], v[82:83], v[116:117] op_sel_hi:[1,0]
v_pk_mul_f32 v[84:85], v[84:85], v[116:117] op_sel_hi:[1,0]
v_pk_mul_f32 v[86:87], v[86:87], v[116:117] op_sel_hi:[1,0]
v_pk_mul_f32 v[88:89], v[88:89], v[116:117] op_sel_hi:[1,0]
v_pk_mul_f32 v[90:91], v[90:91], v[116:117] op_sel_hi:[1,0]
v_pk_mul_f32 v[92:93], v[92:93], v[116:117] op_sel_hi:[1,0]
v_pk_mul_f32 v[94:95], v[94:95], v[116:117] op_sel_hi:[1,0]
v_pk_mul_f32 v[96:97], v[96:97], v[116:117] op_sel_hi:[1,0]
v_pk_mul_f32 v[98:99], v[98:99], v[116:117] op_sel_hi:[1,0]
v_pk_mul_f32 v[100:101], v[100:101], v[116:117] op_sel_hi:[1,0]
v_pk_mul_f32 v[102:103], v[102:103], v[116:117] op_sel_hi:[1,0]
v_pk_mul_f32 v[104:105], v[104:105], v[116:117] op_sel_hi:[1,0]
v_pk_mul_f32 v[106:107], v[106:107], v[116:117] op_sel_hi:[1,0]
v_pk_mul_f32 v[108:109], v[108:109], v[116:117] op_sel_hi:[1,0]
v_pk_mul_f32 v[110:111], v[110:111], v[116:117] op_sel_hi:[1,0]
L_nr_99:
v_mul_f32 v118, s52, v112
v_fma_f32 v72, v72, s51, v118
v_fma_f32 v73, v73, s51, v118
v_fma_f32 v74, v74, s51, v118
v_fma_f32 v75, v75, s51, v118
v_exp_f32 v72, v72
v_exp_f32 v73, v73
v_exp_f32 v74, v74
v_exp_f32 v75, v75
v_cvt_pk_bf16_f32 v78, v72, v73
v_cvt_pk_bf16_f32 v79, v74, v75
v_add_f32 v72, v72, v73
v_add_f32 v74, v74, v75
v_add_f32 v72, v72, v74
v_add_f32 v113, v113, v72
v_mfma_f32_16x16x16_bf16 v[80:83], v[52:53], v[78:79], v[80:83]
v_mfma_f32_16x16x16_bf16 v[84:87], v[54:55], v[78:79], v[84:87]
v_mfma_f32_16x16x16_bf16 v[88:91], v[56:57], v[78:79], v[88:91]
v_mfma_f32_16x16x16_bf16 v[92:95], v[58:59], v[78:79], v[92:95]
v_mfma_f32_16x16x16_bf16 v[96:99], v[60:61], v[78:79], v[96:99]
v_mfma_f32_16x16x16_bf16 v[100:103], v[62:63], v[78:79], v[100:103]
v_mfma_f32_16x16x16_bf16 v[104:107], v[64:65], v[78:79], v[104:107]
v_mfma_f32_16x16x16_bf16 v[108:111], v[66:67], v[78:79], v[108:111]
s_add_u32 s58, s58, 1
s_cmp_eq_u32 s56, 0
s_cbranch_scc1 L_ct_100
s_sub_u32 s57, s57, 1
s_cmp_eq_u32 s57, 0
s_cbranch_scc1 L_sdrained
L_ct_100:
s_cmp_lg_u32 s56, 0
s_cbranch_scc1 L_w0_102
s_cmp_eq_u32 s54, 0
s_cbranch_scc1 L_w1_103
s_cmp_gt_u32 s58, 20
s_cbranch_scc1 L_sw_109
s_waitcnt vmcnt(8)
s_branch L_is_108
L_sw_109:
s_waitcnt vmcnt(9)
s_branch L_is_108
L_w1_103:
s_waitcnt vmcnt(24)
s_branch L_go_101
L_is_108:
v_readfirstlane_b32 s53, v120
s_cmp_ge_u32 s53, 1024
s_cbranch_scc1 L_dr_107
s_add_u32 s49, s53, s63
s_and_b32 s49, s49, 1023
s_lshl_b32 s49, s49, 12
s_add_u32 m0, s45, 0
s_nop 0
buffer_load_dwordx4 v2, s[32:35], s49 offen offset:0 nt lds
buffer_load_dwordx4 v3, s[32:35], s49 offen offset:1024 nt lds
buffer_load_dwordx4 v4, s[32:35], s49 offen offset:2048 nt lds
buffer_load_dwordx4 v5, s[32:35], s49 offen offset:3072 nt lds
s_add_u32 m0, s45, 4096
s_nop 0
buffer_load_dwordx4 v6, s[36:39], s49 offen offset:0 nt lds
buffer_load_dwordx4 v7, s[36:39], s49 offen offset:1024 nt lds
buffer_load_dwordx4 v6, s[36:39], s49 offen offset:2048 nt lds
buffer_load_dwordx4 v7, s[36:39], s49 offen offset:3072 nt lds
s_cmp_lt_u32 s58, 20
s_cbranch_scc1 L_st_110
v_mov_b32 v120, 1
s_mov_b64 exec, 1
global_atomic_add v120, v119, v120, s[30:31] sc0 sc1
s_mov_b64 exec, -1
s_branch L_sd_111
L_st_110:
v_add_u32 v120, 64, v120
L_sd_111:
s_branch L_go_101
L_dr_107:
s_mov_b32 s56, 1
s_mov_b32 s57, 2
s_branch L_go_101
L_w0_102:
s_waitcnt vmcnt(0)
L_go_101:
ds_read_b128 v[36:39], v8 offset:16384
ds_read_b128 v[40:43], v9 offset:16384
ds_read_b128 v[44:47], v10 offset:16384
ds_read_b128 v[48:51], v11 offset:16384
ds_read_b64_tr_b16 v[52:53], v12 offset:16384
ds_read_b64_tr_b16 v[54:55], v13 offset:16384
ds_read_b64_tr_b16 v[56:57], v14 offset:16384
ds_read_b64_tr_b16 v[58:59], v15 offset:16384
ds_read_b64_tr_b16 v[60:61], v16 offset:16384
ds_read_b64_tr_b16 v[62:63], v17 offset:16384
ds_read_b64_tr_b16 v[64:65], v18 offset:16384
ds_read_b64_tr_b16 v[66:67], v19 offset:16384
s_waitcnt lgkmcnt(8)
v_mfma_f32_16x16x32_bf16 v[68:71], v[36:39], v[20:23], 0
v_mfma_f32_16x16x32_bf16 v[68:71], v[40:43], v[24:27], v[68:71]
v_mfma_f32_16x16x32_bf16 v[68:71], v[44:47], v[28:31], v[68:71]
v_mfma_f32_16x16x32_bf16 v[68:71], v[48:51], v[32:35], v[68:71]
s_waitcnt lgkmcnt(0)
L_ni_105:
s_nop 7
v_cvt_pk_bf16_f32 v76, v68, v69
v_cvt_pk_bf16_f32 v77, v70, v71
v_lshlrev_b32 v72, 16, v76
v_and_b32 v73, 0xffff0000, v76
v_lshlrev_b32 v74, 16, v77
v_and_b32 v75, 0xffff0000, v77
v_mul_f32 v72, s50, v72
v_mul_f32 v73, s50, v73
v_mul_f32 v74, s50, v74
v_mul_f32 v75, s50, v75
v_cvt_pk_bf16_f32 v76, v72, v73
v_cvt_pk_bf16_f32 v77, v74, v75
v_lshlrev_b32 v72, 16, v76
v_and_b32 v73, 0xffff0000, v76
v_lshlrev_b32 v74, 16, v77
v_and_b32 v75, 0xffff0000, v77
v_max3_f32 v114, v72, v73, v74
v_max_f32 v114, v114, v75
v_mov_b32 v115, v114
s_nop 1
v_permlane16_swap_b32 v115, v114
v_max_f32 v114, v114, v115
v_mov_b32 v115, v114
s_nop 1
v_permlane32_swap_b32 v115, v114
v_max_f32 v114, v114, v115
v_max_f32 v114, v114, v112
v_cmp_gt_f32 vcc, v114, v112
s_cbranch_vccz L_nr_112
v_sub_f32 v116, v112, v114
v_mul_f32 v116, s51, v116
v_exp_f32 v116, v116
v_mov_b32 v112, v114
v_mul_f32 v113, v113, v116
v_pk_mul_f32 v[80:81], v[80:81], v[116:117] op_sel_hi:[1,0]
v_pk_mul_f32 v[82:83], v[82:83], v[116:117] op_sel_hi:[1,0]
v_pk_mul_f32 v[84:85], v[84:85], v[116:117] op_sel_hi:[1,0]
v_pk_mul_f32 v[86:87], v[86:87], v[116:117] op_sel_hi:[1,0]
v_pk_mul_f32 v[88:89], v[88:89], v[116:117] op_sel_hi:[1,0]
v_pk_mul_f32 v[90:91], v[90:91], v[116:117] op_sel_hi:[1,0]
v_pk_mul_f32 v[92:93], v[92:93], v[116:117] op_sel_hi:[1,0]
v_pk_mul_f32 v[94:95], v[94:95], v[116:117] op_sel_hi:[1,0]
v_pk_mul_f32 v[96:97], v[96:97], v[116:117] op_sel_hi:[1,0]
v_pk_mul_f32 v[98:99], v[98:99], v[116:117] op_sel_hi:[1,0]
v_pk_mul_f32 v[100:101], v[100:101], v[116:117] op_sel_hi:[1,0]
v_pk_mul_f32 v[102:103], v[102:103], v[116:117] op_sel_hi:[1,0]
v_pk_mul_f32 v[104:105], v[104:105], v[116:117] op_sel_hi:[1,0]
v_pk_mul_f32 v[106:107], v[106:107], v[116:117] op_sel_hi:[1,0]
v_pk_mul_f32 v[108:109], v[108:109], v[116:117] op_sel_hi:[1,0]
v_pk_mul_f32 v[110:111], v[110:111], v[116:117] op_sel_hi:[1,0]
L_nr_112:
v_mul_f32 v118, s52, v112
v_fma_f32 v72, v72, s51, v118
v_fma_f32 v73, v73, s51, v118
v_fma_f32 v74, v74, s51, v118
v_fma_f32 v75, v75, s51, v118
v_exp_f32 v72, v72
v_exp_f32 v73, v73
v_exp_f32 v74, v74
v_exp_f32 v75, v75
v_cvt_pk_bf16_f32 v78, v72, v73
v_cvt_pk_bf16_f32 v79, v74, v75
v_add_f32 v72, v72, v73
v_add_f32 v74, v74, v75
v_add_f32 v72, v72, v74
v_add_f32 v113, v113, v72
v_mfma_f32_16x16x16_bf16 v[80:83], v[52:53], v[78:79], v[80:83]
v_mfma_f32_16x16x16_bf16 v[84:87], v[54:55], v[78:79], v[84:87]
v_mfma_f32_16x16x16_bf16 v[88:91], v[56:57], v[78:79], v[88:91]
v_mfma_f32_16x16x16_bf16 v[92:95], v[58:59], v[78:79], v[92:95]
v_mfma_f32_16x16x16_bf16 v[96:99], v[60:61], v[78:79], v[96:99]
v_mfma_f32_16x16x16_bf16 v[100:103], v[62:63], v[78:79], v[100:103]
v_mfma_f32_16x16x16_bf16 v[104:107], v[64:65], v[78:79], v[104:107]
v_mfma_f32_16x16x16_bf16 v[108:111], v[66:67], v[78:79], v[108:111]
s_add_u32 s58, s58, 1
s_cmp_eq_u32 s56, 0
s_cbranch_scc1 L_ct_113
s_sub_u32 s57, s57, 1
s_cmp_eq_u32 s57, 0
s_cbranch_scc1 L_sdrained
L_ct_113:
s_cmp_lg_u32 s56, 0
s_cbranch_scc1 L_w0_115
s_cmp_eq_u32 s54, 0
s_cbranch_scc1 L_w1_116
s_cmp_gt_u32 s58, 20
s_cbranch_scc1 L_sw_122
s_waitcnt vmcnt(8)
s_branch L_is_121
L_sw_122:
s_waitcnt vmcnt(9)
s_branch L_is_121
L_w1_116:
s_waitcnt vmcnt(16)
s_branch L_go_114
L_is_121:
v_readfirstlane_b32 s53, v121
s_cmp_ge_u32 s53, 1024
s_cbranch_scc1 L_dr_120
s_add_u32 s49, s53, s63
s_and_b32 s49, s49, 1023
s_lshl_b32 s49, s49, 12
s_add_u32 m0, s45, 8192
s_nop 0
buffer_load_dwordx4 v2, s[32:35], s49 offen offset:0 nt lds
buffer_load_dwordx4 v3, s[32:35], s49 offen offset:1024 nt lds
buffer_load_dwordx4 v4, s[32:35], s49 offen offset:2048 nt lds
buffer_load_dwordx4 v5, s[32:35], s49 offen offset:3072 nt lds
s_add_u32 m0, s45, 12288
s_nop 0
buffer_load_dwordx4 v6, s[36:39], s49 offen offset:0 nt lds
buffer_load_dwordx4 v7, s[36:39], s49 offen offset:1024 nt lds
buffer_load_dwordx4 v6, s[36:39], s49 offen offset:2048 nt lds
buffer_load_dwordx4 v7, s[36:39], s49 offen offset:3072 nt lds
s_cmp_lt_u32 s58, 20
s_cbranch_scc1 L_st_123
v_mov_b32 v121, 1
s_mov_b64 exec, 1
global_atomic_add v121, v119, v121, s[30:31] sc0 sc1
s_mov_b64 exec, -1
s_branch L_sd_124
L_st_123:
v_add_u32 v121, 64, v121
L_sd_124:
s_branch L_go_114
L_dr_120:
s_mov_b32 s56, 1
s_mov_b32 s57, 2
s_branch L_go_114
L_w0_115:
s_waitcnt vmcnt(0)
L_go_114:
ds_read_b128 v[36:39], v8 offset:24576
ds_read_b128 v[40:43], v9 offset:24576
ds_read_b128 v[44:47], v10 offset:24576
ds_read_b128 v[48:51], v11 offset:24576
ds_read_b64_tr_b16 v[52:53], v12 offset:24576
ds_read_b64_tr_b16 v[54:55], v13 offset:24576
ds_read_b64_tr_b16 v[56:57], v14 offset:24576
ds_read_b64_tr_b16 v[58:59], v15 offset:24576
ds_read_b64_tr_b16 v[60:61], v16 offset:24576
ds_read_b64_tr_b16 v[62:63], v17 offset:24576
ds_read_b64_tr_b16 v[64:65], v18 offset:24576
ds_read_b64_tr_b16 v[66:67], v19 offset:24576
s_waitcnt lgkmcnt(8)
v_mfma_f32_16x16x32_bf16 v[68:71], v[36:39], v[20:23], 0
v_mfma_f32_16x16x32_bf16 v[68:71], v[40:43], v[24:27], v[68:71]
v_mfma_f32_16x16x32_bf16 v[68:71], v[44:47], v[28:31], v[68:71]
v_mfma_f32_16x16x32_bf16 v[68:71], v[48:51], v[32:35], v[68:71]
s_waitcnt lgkmcnt(0)
L_ni_118:
s_nop 7
v_cvt_pk_bf16_f32 v76, v68, v69
v_cvt_pk_bf16_f32 v77, v70, v71
v_lshlrev_b32 v72, 16, v76
v_and_b32 v73, 0xffff0000, v76
v_lshlrev_b32 v74, 16, v77
v_and_b32 v75, 0xffff0000, v77
v_mul_f32 v72, s50, v72
v_mul_f32 v73, s50, v73
v_mul_f32 v74, s50, v74
v_mul_f32 v75, s50, v75
v_cvt_pk_bf16_f32 v76, v72, v73
v_cvt_pk_bf16_f32 v77, v74, v75
v_lshlrev_b32 v72, 16, v76
v_and_b32 v73, 0xffff0000, v76
v_lshlrev_b32 v74, 16, v77
v_and_b32 v75, 0xffff0000, v77
v_max3_f32 v114, v72, v73, v74
v_max_f32 v114, v114, v75
v_mov_b32 v115, v114
s_nop 1
v_permlane16_swap_b32 v115, v114
v_max_f32 v114, v114, v115
v_mov_b32 v115, v114
s_nop 1
v_permlane32_swap_b32 v115, v114
v_max_f32 v114, v114, v115
v_max_f32 v114, v114, v112
v_cmp_gt_f32 vcc, v114, v112
s_cbranch_vccz L_nr_125
v_sub_f32 v116, v112, v114
v_mul_f32 v116, s51, v116
v_exp_f32 v116, v116
v_mov_b32 v112, v114
v_mul_f32 v113, v113, v116
v_pk_mul_f32 v[80:81], v[80:81], v[116:117] op_sel_hi:[1,0]
v_pk_mul_f32 v[82:83], v[82:83], v[116:117] op_sel_hi:[1,0]
v_pk_mul_f32 v[84:85], v[84:85], v[116:117] op_sel_hi:[1,0]
v_pk_mul_f32 v[86:87], v[86:87], v[116:117] op_sel_hi:[1,0]
v_pk_mul_f32 v[88:89], v[88:89], v[116:117] op_sel_hi:[1,0]
v_pk_mul_f32 v[90:91], v[90:91], v[116:117] op_sel_hi:[1,0]
v_pk_mul_f32 v[92:93], v[92:93], v[116:117] op_sel_hi:[1,0]
v_pk_mul_f32 v[94:95], v[94:95], v[116:117] op_sel_hi:[1,0]
v_pk_mul_f32 v[96:97], v[96:97], v[116:117] op_sel_hi:[1,0]
v_pk_mul_f32 v[98:99], v[98:99], v[116:117] op_sel_hi:[1,0]
v_pk_mul_f32 v[100:101], v[100:101], v[116:117] op_sel_hi:[1,0]
v_pk_mul_f32 v[102:103], v[102:103], v[116:117] op_sel_hi:[1,0]
v_pk_mul_f32 v[104:105], v[104:105], v[116:117] op_sel_hi:[1,0]
v_pk_mul_f32 v[106:107], v[106:107], v[116:117] op_sel_hi:[1,0]
v_pk_mul_f32 v[108:109], v[108:109], v[116:117] op_sel_hi:[1,0]
v_pk_mul_f32 v[110:111], v[110:111], v[116:117] op_sel_hi:[1,0]
L_nr_125:
v_mul_f32 v118, s52, v112
v_fma_f32 v72, v72, s51, v118
v_fma_f32 v73, v73, s51, v118
v_fma_f32 v74, v74, s51, v118
v_fma_f32 v75, v75, s51, v118
v_exp_f32 v72, v72
v_exp_f32 v73, v73
v_exp_f32 v74, v74
v_exp_f32 v75, v75
v_cvt_pk_bf16_f32 v78, v72, v73
v_cvt_pk_bf16_f32 v79, v74, v75
v_add_f32 v72, v72, v73
v_add_f32 v74, v74, v75
v_add_f32 v72, v72, v74
v_add_f32 v113, v113, v72
v_mfma_f32_16x16x16_bf16 v[80:83], v[52:53], v[78:79], v[80:83]
v_mfma_f32_16x16x16_bf16 v[84:87], v[54:55], v[78:79], v[84:87]
v_mfma_f32_16x16x16_bf16 v[88:91], v[56:57], v[78:79], v[88:91]
v_mfma_f32_16x16x16_bf16 v[92:95], v[58:59], v[78:79], v[92:95]
v_mfma_f32_16x16x16_bf16 v[96:99], v[60:61], v[78:79], v[96:99]
v_mfma_f32_16x16x16_bf16 v[100:103], v[62:63], v[78:79], v[100:103]
v_mfma_f32_16x16x16_bf16 v[104:107], v[64:65], v[78:79], v[104:107]
v_mfma_f32_16x16x16_bf16 v[108:111], v[66:67], v[78:79], v[108:111]
s_add_u32 s58, s58, 1
s_cmp_eq_u32 s56, 0
s_cbranch_scc1 L_ct_126
s_sub_u32 s57, s57, 1
s_cmp_eq_u32 s57, 0
s_cbranch_scc1 L_sdrained
L_ct_126:
s_add_u32 s54, s54, 1
s_branch L_sloop
L_sdrained:
v_mov_b32 v115, v113
s_nop 1
v_permlane16_swap_b32 v115, v113
v_add_f32 v113, v113, v115
v_mov_b32 v115, v113
s_nop 1
v_permlane32_swap_b32 v115, v113
v_add_f32 v113, v113, v115
v_mov_b32 v116, v112
v_mov_b32 v117, v113
s_mov_b64 exec, s[42:43]
ds_write_b128 v122, v[80:83] offset:0
ds_write_b128 v122, v[84:87] offset:64
ds_write_b128 v122, v[88:91] offset:128
ds_write_b128 v122, v[92:95] offset:192
ds_write_b128 v122, v[96:99] offset:256
ds_write_b128 v122, v[100:103] offset:320
ds_write_b128 v122, v[104:107] offset:384
ds_write_b128 v122, v[108:111] offset:448
s_mov_b64 exec, 3
ds_write_b64 v123, v[116:117] offset:1024
s_mov_b64 exec, -1
s_waitcnt lgkmcnt(0)
s_barrier
s_cmp_lg_u32 s3, 0
s_cbranch_scc1 L_sdone
v_mov_b32 v4, v124
v_mov_b32 v5, v125
ds_read_b64 v[8:9], v5 offset:0
ds_read_b64 v[10:11], v5 offset:1056
ds_read_b64 v[12:13], v5 offset:2112
ds_read_b64 v[14:15], v5 offset:3168
ds_read_b128 v[16:19], v4 offset:0
ds_read_b128 v[20:23], v4 offset:1056
ds_read_b128 v[24:27], v4 offset:2112
ds_read_b128 v[28:31], v4 offset:3168
s_waitcnt lgkmcnt(4)
v_max3_f32 v6, v8, v10, v12
v_max_f32 v6, v6, v14
v_sub_f32 v8, v8, v6
v_mul_f32 v8, s51, v8
v_sub_f32 v10, v10, v6
v_mul_f32 v10, s51, v10
v_sub_f32 v12, v12, v6
v_mul_f32 v12, s51, v12
v_sub_f32 v14, v14, v6
v_mul_f32 v14, s51, v14
v_exp_f32 v8, v8
v_exp_f32 v10, v10
v_exp_f32 v12, v12
v_exp_f32 v14, v14
v_mul_f32 v7, v8, v9
v_fmac_f32 v7, v10, v11
v_fmac_f32 v7, v12, v13
v_fmac_f32 v7, v14, v15
s_waitcnt lgkmcnt(0)
v_mul_f32 v32, v8, v16
v_fmac_f32 v32, v10, v20
v_fmac_f32 v32, v12, v24
v_fmac_f32 v32, v14, v28
v_mul_f32 v33, v8, v17
v_fmac_f32 v33, v10, v21
v_fmac_f32 v33, v12, v25
v_fmac_f32 v33, v14, v29
v_mul_f32 v34, v8, v18
v_fmac_f32 v34, v10, v22
v_fmac_f32 v34, v12, v26
v_fmac_f32 v34, v14, v30
v_mul_f32 v35, v8, v19
v_fmac_f32 v35, v10, v23
v_fmac_f32 v35, v12, v27
v_fmac_f32 v35, v14, v31
v_min_u32 v32, -2, v32
v_min_u32 v33, -2, v33
v_min_u32 v34, -2, v34
v_min_u32 v35, -2, v35
v_min_u32 v6, -2, v6
v_min_u32 v7, -2, v7
v_mov_b32 v2, v126
v_mov_b32 v3, v127
global_store_dwordx4 v2, v[32:35], s[30:31] sc0 sc1
s_mov_b32 s56, 1
s_mov_b32 s57, 1
s_mov_b64 exec, s[56:57]
global_store_dwordx2 v3, v[6:7], s[30:31] offset:1024 sc0 sc1
v_mov_b32 v4, 161944
v_mov_b32 v5, 1
s_mov_b64 exec, 1
ds_write_b32 v4, v5
s_mov_b64 exec, -1
L_sdone:
s_endpgm
L_fail:
s_waitcnt vmcnt(0) lgkmcnt(0)
s_mov_b64 exec, 1
s_lshl_b32 s75, s2, 8
s_or_b32 s74, s74, s75
s_lshl_b32 s75, s3, 4
s_or_b32 s74, s74, s75
v_mov_b32 v2, 32
v_mov_b32 v3, s74
global_store_dword v2, v3, s[28:29] sc0 sc1
s_waitcnt vmcnt(0)
L_exit:
s_endpgm
.p2align 2
L_tab:
.long 0x403, 0x406813, 0xa28423, 0xd3b433, 0x1452443, 0x182b853, 0x56e463, 0x639873
.long 0x101407, 0x715417, 0xb10827, 0x101c837, 0x1553447, 0x1b67457, 0x1a7b467, 0xc83477
.long 0x20080b, 0x80781b, 0xe2942b, 0x113e43b, 0x165444b, 0x1c6845b, 0x1e3486b, 0x138747b
.long 0x30240f, 0x91641f, 0xf2a42f, 0x123f43f, 0x175544f, 0x1d6945f, 0x1f3586f, 0x198a47f
.long 0x403483, 0xa08893, 0x102b4a3, 0xe3c4b3, 0x18564c3, 0x17cd3, 0x26c4e3, 0x17e4f3
.long 0x504487, 0xb17497, 0x112c4a7, 0x15404b7, 0x19574c7, 0x142a8d7, 0x32d8e7, 0xd844f7
.long 0x80548b, 0xc1849b, 0x122d4ab, 0x16414bb, 0x1c248cb, 0x1e6a4db, 0x66f4eb, 0x1a8b4fb
.long 0x90648f, 0xf1949f, 0x132e4af, 0x17424bf, 0x1d584cf, 0x1f6b4df, 0x1b7c4ef, 0x1c8d4ff
.long 0xa07503, 0x1009913, 0x40dc22, 0x30001a, 0x212c12, 0x118c0a, 0x2c802, 0x36806
.long 0xb01907, 0x111a517, 0x50ec2e, 0x418826, 0x313c1e, 0x219c16, 0x11fc0e, 0x70003a
.long 0xc0850b, 0x121b51b, 0xc11862, 0xb0005a, 0xa15c52, 0x91bc4a, 0x82f842, 0x83a846
.long 0xd0290f, 0x131c51f, 0xd1286e, 0xc1b866, 0xb2285e, 0xa26856, 0x920c4e, 0xf0007a
.long 0x600c32, 0x506c2a, 0x14138a2, 0x131d89a, 0x1216c92, 0x112888a, 0x1031882, 0x103c886
.long 0x701c3e, 0x607c36, 0x150fcae, 0x1411ca6, 0x130009e, 0x1229896, 0x1121c8e, 0x17000ba
.long 0xe02c72, 0xd08c6a, 0x1c158e2, 0x1b000da, 0x1a000d2, 0x191dcca, 0x18328c2, 0x1823cc6
.long 0xf0007e, 0xe09c76, 0x1d10cee, 0x1c1e8e6, 0x1b000de, 0x1a1ecd6, 0x1922cce, 0x1f3f8fa
.long 0x1603cb2, 0x150acaa, 0x70e849, 0x116851, 0x414c5d, 0x35a459, 0x72e861, 0x27f455
.long 0x17000be, 0x160bcb6, 0x60d86d, 0x537469, 0x84b471, 0xe61479, 0xf7447d, 0x981475
.long 0x1e04cf2, 0x1d0ccea, 0x162f489, 0x1a45495, 0x1e594a1, 0x45b4a9, 0x1d7d49d, 0x1b8c499
.long 0x1f000fe, 0x1e0b8f6, 0x244ad, 0x2178b5, 0x1494b1, 0x55c4bd, 0xa308c1, 0x3378b9
.long 0x140a465, 0x5c4d, 0x80f8d1, 0x6384c9, 0x7218cd, 0xb5f4d5, 0x46d400, 0x480400
.long 0x150b481, 0x171e485, 0x10c800, 0x36400, 0x48400, 0x65d400, 0xb70400, 0x538800
.long 0x180c48d, 0x1920491, 0x225400, 0x719800, 0x520800, 0x75e400, 0xc71400, 0xa3b800
.long 0x10038c5, 0x1f234a5, 0x326400, 0x81a800, 0x64a400, 0x81ac00, 0xd72400, 0xb82400
.long 0x1104800, 0x112400, 0x927400, 0x939400, 0x94c400, 0xc1cc00, 0xe73400, 0xe85400
.long 0x1209400, 0x213400, 0x1730400, 0xa3a400, 0xc4d400, 0xd60400, 0x1275400, 0x1186400
.long 0x1305800, 0x314400, 0x1814800, 0xf3d400, 0xd4e400, 0xf62400, 0x1376400, 0x123d800
.long 0x190d400, 0x141d400, 0x1931400, 0x1843400, 0xe4f400, 0x1027800, 0x1477400, 0x143e800
.long 0x1a0e400, 0x181f400, 0x1a32400, 0x1944400, 0xf50400, 0x1363400, 0x1578400, 0x1588400
.long 0x1b0f400, 0x1a21400, 0x1b33400, 0x1d46400, 0x1023800, 0x1564400, 0x1679400, 0x1689400
.long 0x1c10400, 0x1b22400, 0x1e34400, 0x1e1f800, 0x1151400, 0x1665400, 0x177a400, 0x1d8e400
.long 0x1d11400, 0x1c0a800, 0x1f35400, 0x1f47400, 0x1f25800, 0x1766400, 0x1c33800, 0x1e8f400
.section .rodata,"a"
.p2align 6
.amdhsa_kernel adaLN_cond__gqa_block_cached__swiglu_ffn__decode_kernel
.amdhsa_next_free_vgpr 256
.amdhsa_next_free_sgpr 102
.amdhsa_accum_offset 256
.amdhsa_group_segment_fixed_size 0
.amdhsa_kernarg_size 112
.amdhsa_user_sgpr_count 2
.amdhsa_user_sgpr_kernarg_segment_ptr 1
.amdhsa_system_sgpr_workgroup_id_x 1
.end_amdhsa_kernel
.text
```
